```python
import torch

def _softmax(x, axis=-1):
    return torch.softmax(x, dim=axis)

def _gelu(x):
    return torch.nn.functional.gelu(x, approximate='tanh')

def _silu(x):
    return torch.nn.functional.silu(x)

def _sigmoid(x):
    return torch.sigmoid(x)

def _layernorm(x, axis=-1, eps=1e-05):
    m = x.mean(dim=axis, keepdim=True)
    v = x.var(dim=axis, keepdim=True, unbiased=False)
    return (x - m) / torch.sqrt(v + eps)

def _scatter_add(tgt, idx, src, axis=0):
    return tgt.clone().index_add_(axis, idx, src)

def _segment_sum(src, seg, n):
    out = torch.zeros((n,) + src.shape[1:], dtype=src.dtype)
    return out.index_add_(0, seg, src)

def _pad(x, pw):
    flat = tuple((v for pair in reversed(pw) for v in pair))
    return torch.nn.functional.pad(x, flat)
kernel_name = 'adaLN_cond__mha_block_cached__geglu_ffn__decode'

def setup_inputs():

    _w = lambda a: (lambda t: t.to(torch.bfloat16) if t.is_floating_point() else t)(torch.as_tensor(a))

    def _A_setup():
        B, Sq, D = (4, 1, 512)
        H, Sk, Dh = (32, 8192, 128)
        return {'x': _w((lambda *s: torch.randn(*s, dtype=torch.bfloat16) * 0.05)(B, Sq, D)), 'k_cache': _w((lambda *s: torch.randn(*s, dtype=torch.bfloat16) * 3.2)(B, H, Sk, Dh)), 'v_cache': _w((lambda *s: torch.randn(*s, dtype=torch.bfloat16) * 0.4)(B, H, Sk, Dh)), 'wq': _w((lambda *s: torch.randn(*s, dtype=torch.bfloat16) * 3.2)(D, H * Dh) * D ** (-0.5)), 'wo': _w((lambda *s: torch.randn(*s, dtype=torch.bfloat16) * 0.4)(H * Dh, D) * (H * Dh) ** (-0.5))}
    _A_in = _A_setup()

    def _B_setup():
        B, S, D, F = (4, 1, 512, 1792)
        return {'x': _w((lambda *s: torch.randn(*s, dtype=torch.bfloat16) * 0.05)(B, S, D)), 'w_gate': _w((lambda *s: torch.randn(*s, dtype=torch.bfloat16) * 0.05)(D, F)), 'w_up': _w((lambda *s: torch.randn(*s, dtype=torch.bfloat16) * 0.05)(D, F)), 'w_down': _w((lambda *s: torch.randn(*s, dtype=torch.bfloat16) * 0.05)(F, D))}
    _B_in = _B_setup()
    return {'A_x': _A_in['x'], 'A_k_cache': _A_in['k_cache'], 'A_v_cache': _A_in['v_cache'], 'A_wq': _A_in['wq'], 'A_wo': _A_in['wo'], 'B_x': _B_in['x'], 'B_w_gate': _B_in['w_gate'], 'B_w_up': _B_in['w_up'], 'B_w_down': _B_in['w_down'], 'c': _w((lambda *s: torch.randn(*s, dtype=torch.bfloat16) * 0.1)(4, 512) * 8.0), 'w_mod': _w((lambda *s: torch.randn(*s, dtype=torch.bfloat16) * 0.1)(512, 6 * 512) * 512 ** (-0.5) * 8.0)}

def reference(A_x, A_k_cache, A_v_cache, A_wq, A_wo, B_x, B_w_gate, B_w_up, B_w_down, c, w_mod):

    def _A_ref(x, k_cache, v_cache, wq, wo):
        B, Sq, D = x.shape
        H, Dh = (32, 128)
        q = (lambda x, *d: x.permute(*d))((x @ wq).reshape(B, Sq, H, Dh), 0, 2, 1, 3)
        scores = torch.einsum('bhqd,bhkd->bhqk', q, k_cache) * Dh ** (-0.5)
        p = _softmax(scores, axis=-1)
        o = torch.einsum('bhqk,bhkd->bhqd', p, v_cache)
        return (lambda x, *d: x.permute(*d))(o, 0, 2, 1, 3).reshape(B, Sq, H * Dh) @ wo

    def _B_ref(x, w_gate, w_up, w_down):
        return _gelu(x @ w_gate) * (x @ w_up) @ w_down
    x = A_x
    mod = (_silu(c) @ w_mod).reshape(c.shape[0], 6, 1, -1)
    sa, ca, ga, sb, cb, gb = (mod[:, 0].clone(), mod[:, 1].clone(), mod[:, 2].clone(), mod[:, 3].clone(), mod[:, 4].clone(), mod[:, 5].clone())
    h = _layernorm(x, axis=-1) * (1 + ca) + sa
    x = x + ga * _A_ref(h, A_k_cache, A_v_cache, A_wq, A_wo)
    h = _layernorm(x, axis=-1) * (1 + cb) + sb
    x = x + gb * _B_ref(h, B_w_gate, B_w_up, B_w_down)
    return x
```

```asm
; @launch grid=(256,1,1) block=(512,1,1) lds=151552
    .amdgcn_target "amdgcn-amd-amdhsa--gfx950"
    .text
    .globl adaLN_cond__mha_block_cached__geglu_ffn__decode_kernel
    .p2align 8
    .type adaLN_cond__mha_block_cached__geglu_ffn__decode_kernel,@function
adaLN_cond__mha_block_cached__geglu_ffn__decode_kernel:
    s_cmp_ge_u32 s2, 256
    s_cbranch_scc1 L_end
    s_load_dwordx16 s[16:31], s[0:1], 0
    s_load_dwordx8 s[32:39], s[0:1], 64
    s_load_dwordx4 s[40:43], s[0:1], 96
    v_lshrrev_b32 v1, 6, v0
    v_and_b32 v0, 63, v0
    v_readfirstlane_b32 s3, v1
    v_lshlrev_b32 v12, 2, v0
    v_mov_b32 v13, 0
    ds_write_b32 v12, v13 offset:0
    s_bfe_u32 s58, s2, 0x10003
    s_and_b32 s59, s2, 3
    s_bfe_u32 s4, s2, 0x20004
    s_lshl_b32 s4, s4, 2
    s_or_b32 s59, s59, s4
    s_and_b32 s4, s2, 4
    s_lshl_b32 s4, s4, 2
    s_or_b32 s59, s59, s4
    s_lshr_b32 s4, s2, 6
    s_lshl_b32 s4, s4, 5
    s_or_b32 s59, s59, s4
    s_lshr_b32 s56, s2, 6
    s_and_b32 s57, s59, 31
    s_lshl_b32 s15, s59, 1
    s_or_b32 s15, s15, s58
    s_and_b32 s68, s2, 7
    s_lshr_b32 s69, s2, 3
    s_and_b32 s61, s3, 3
    s_cmp_ge_u32 s3, 4
    s_cbranch_scc1 L_helper
    v_and_b32 v12, 3, v0
    v_lshrrev_b32 v13, 4, v0
    v_lshlrev_b32 v1, 6, v12
    v_lshl_add_u32 v1, v13, 4, v1
    v_bfe_u32 v12, v0, 2, 1
    v_lshl_add_u32 v1, v12, 8, v1
    v_bfe_u32 v12, v0, 3, 1
    v_lshl_add_u32 v1, v12, 16, v1
    v_and_b32 v2, 15, v0
    v_lshlrev_b32 v2, 4, v2
    v_bfe_u32 v12, v0, 4, 1
    v_lshl_add_u32 v2, v12, 8, v2
    v_lshrrev_b32 v12, 5, v0
    v_lshl_add_u32 v2, v12, 16, v2
    s_and_b32 s4, s3, 1
    s_lshl_b32 s4, s4, 11
    s_lshr_b32 s5, s3, 1
    s_lshl_b32 s5, s5, 12
    s_add_u32 s4, s4, s5
    v_add_u32 v1, s4, v1
    v_add_u32 v2, s4, v2
    s_lshl_b32 s5, s15, 20
    s_waitcnt lgkmcnt(0)
    s_add_u32 s44, s18, s5
    s_addc_u32 s45, s19, 0
    s_mov_b32 s46, 0x100000
    s_mov_b32 s47, 0x20000
    s_mov_b32 s54, 0
    buffer_load_dwordx4 v[128:131], v1, s[44:47], s54 offen offset:0 nt
    s_mov_b32 s54, 0
    buffer_load_dwordx4 v[132:135], v1, s[44:47], s54 offen offset:512 nt
    s_mov_b32 s54, 0
    buffer_load_dwordx4 v[136:139], v1, s[44:47], s54 offen offset:1024 nt
    s_mov_b32 s54, 0
    buffer_load_dwordx4 v[140:143], v1, s[44:47], s54 offen offset:1536 nt
    s_mov_b32 s54, 8192
    buffer_load_dwordx4 v[144:147], v1, s[44:47], s54 offen offset:0 nt
    s_barrier
    s_load_dword s14, s[42:43], 0
    s_mov_b32 s48, s44
    s_mov_b32 s49, s45
    s_mov_b32 s50, 0x100000
    s_mov_b32 s51, 0x20000
    s_mov_b32 s62, 0x22222222
    s_mov_b32 s63, 0x22222222
    s_mov_b32 s64, 0x44444444
    s_mov_b32 s65, 0x44444444
    s_mov_b32 s66, 0x88888888
    s_mov_b32 s67, 0x88888888
    s_lshl_b32 s4, s3, 13
    s_lshl_b32 s5, s58, 12
    s_add_u32 s4, s4, s5
    s_add_u32 s4, s4, 53248
    v_and_b32 v12, 3, v0
    v_lshl_add_u32 v5, v12, 6, s4
    v_and_b32 v12, 60, v0
    v_add_u32 v5, v12, v5
    v_mov_b32 v6, 0xff7fffff
    v_mov_b32 v7, 0
    v_mov_b32 v4, v1
    s_lshl_b32 s10, s3, 14
    s_add_u32 s10, s10, 86016
    s_waitcnt vmcnt(4)
    s_mov_b32 s54, 8192
    buffer_load_dwordx4 v[148:151], v1, s[44:47], s54 offen offset:512 nt
    s_waitcnt vmcnt(4)
    s_mov_b32 s54, 8192
    buffer_load_dwordx4 v[152:155], v1, s[44:47], s54 offen offset:1024 nt
    s_waitcnt vmcnt(4)
    s_mov_b32 s54, 8192
    buffer_load_dwordx4 v[156:159], v1, s[44:47], s54 offen offset:1536 nt
    s_waitcnt vmcnt(4)
    s_mov_b32 s54, 16384
    buffer_load_dwordx4 v[160:163], v1, s[44:47], s54 offen offset:0 nt
    s_waitcnt vmcnt(4)
    s_mov_b32 s54, 16384
    buffer_load_dwordx4 v[164:167], v1, s[44:47], s54 offen offset:512 nt
    s_waitcnt vmcnt(4)
    s_mov_b32 s54, 16384
    buffer_load_dwordx4 v[168:171], v1, s[44:47], s54 offen offset:1024 nt
    s_waitcnt vmcnt(4)
    s_mov_b32 s54, 16384
    buffer_load_dwordx4 v[172:175], v1, s[44:47], s54 offen offset:1536 nt
    s_waitcnt vmcnt(4)
    s_mov_b32 s54, 24576
    buffer_load_dwordx4 v[176:179], v1, s[44:47], s54 offen offset:0 nt
    s_waitcnt vmcnt(4)
    s_mov_b32 s54, 24576
    buffer_load_dwordx4 v[180:183], v1, s[44:47], s54 offen offset:512 nt
    s_waitcnt vmcnt(4)
    s_mov_b32 s54, 24576
    buffer_load_dwordx4 v[184:187], v1, s[44:47], s54 offen offset:1024 nt
    s_waitcnt vmcnt(4)
    s_mov_b32 s54, 24576
    buffer_load_dwordx4 v[188:191], v1, s[44:47], s54 offen offset:1536 nt
    s_waitcnt vmcnt(4)
    s_mov_b32 s54, 32768
    s_add_u32 m0, s10, 0
    s_nop 0
    buffer_load_dwordx4 v1, s[44:47], s54 offen offset:0 nt lds
    s_waitcnt vmcnt(4)
    s_mov_b32 s54, 32768
    s_add_u32 m0, s10, 512
    s_nop 0
    buffer_load_dwordx4 v1, s[44:47], s54 offen offset:512 nt lds
    s_waitcnt vmcnt(4)
    s_mov_b32 s54, 32768
    s_add_u32 m0, s10, 1024
    s_nop 0
    buffer_load_dwordx4 v1, s[44:47], s54 offen offset:1024 nt lds
    s_waitcnt vmcnt(4)
    s_mov_b32 s54, 32768
    s_add_u32 m0, s10, 1536
    s_nop 0
    buffer_load_dwordx4 v1, s[44:47], s54 offen offset:1536 nt lds
    s_waitcnt vmcnt(4)
    s_mov_b32 s54, 40960
    s_add_u32 m0, s10, 4096
    s_nop 0
    buffer_load_dwordx4 v1, s[44:47], s54 offen offset:0 nt lds
    s_waitcnt vmcnt(4)
    s_mov_b32 s54, 40960
    s_add_u32 m0, s10, 4608
    s_nop 0
    buffer_load_dwordx4 v1, s[44:47], s54 offen offset:512 nt lds
    s_waitcnt vmcnt(4)
    s_mov_b32 s54, 40960
    s_add_u32 m0, s10, 5120
    s_nop 0
    buffer_load_dwordx4 v1, s[44:47], s54 offen offset:1024 nt lds
    s_waitcnt vmcnt(4)
    s_mov_b32 s54, 40960
    s_add_u32 m0, s10, 5632
    s_nop 0
    buffer_load_dwordx4 v1, s[44:47], s54 offen offset:1536 nt lds
    s_waitcnt vmcnt(4)
    s_mov_b32 s54, 49152
    s_add_u32 m0, s10, 8192
    s_nop 0
    buffer_load_dwordx4 v1, s[44:47], s54 offen offset:0 nt lds
    v_mov_b32 v12, 0
    v_mov_b32 v13, 1
    ds_max_u32 v12, v13 offset:60
    s_waitcnt vmcnt(4)
    s_mov_b32 s54, 49152
    s_add_u32 m0, s10, 8704
    s_nop 0
    buffer_load_dwordx4 v1, s[44:47], s54 offen offset:512 nt lds
    s_waitcnt vmcnt(4)
    s_mov_b32 s54, 49152
    s_add_u32 m0, s10, 9216
    s_nop 0
    buffer_load_dwordx4 v1, s[44:47], s54 offen offset:1024 nt lds
    s_waitcnt vmcnt(4)
    s_mov_b32 s54, 49152
    s_add_u32 m0, s10, 9728
    s_nop 0
    buffer_load_dwordx4 v1, s[44:47], s54 offen offset:1536 nt lds
    s_waitcnt vmcnt(4)
    s_mov_b32 s54, 57344
    s_add_u32 m0, s10, 12288
    s_nop 0
    buffer_load_dwordx4 v1, s[44:47], s54 offen offset:0 nt lds
    s_waitcnt vmcnt(4)
    s_mov_b32 s54, 57344
    s_add_u32 m0, s10, 12800
    s_nop 0
    buffer_load_dwordx4 v1, s[44:47], s54 offen offset:512 nt lds
    s_waitcnt vmcnt(4)
    s_mov_b32 s54, 57344
    s_add_u32 m0, s10, 13312
    s_nop 0
    buffer_load_dwordx4 v1, s[44:47], s54 offen offset:1024 nt lds
    s_waitcnt vmcnt(4)
    s_mov_b32 s54, 57344
    s_add_u32 m0, s10, 13824
    s_nop 0
    buffer_load_dwordx4 v1, s[44:47], s54 offen offset:1536 nt lds
    s_waitcnt vmcnt(4)
    s_mov_b32 s54, 131072
    buffer_load_dwordx4 v[192:195], v1, s[44:47], s54 offen offset:0 nt
    s_waitcnt vmcnt(4)
    s_mov_b32 s54, 131072
    buffer_load_dwordx4 v[196:199], v1, s[44:47], s54 offen offset:512 nt
    s_waitcnt vmcnt(4)
    s_mov_b32 s54, 131072
    buffer_load_dwordx4 v[200:203], v1, s[44:47], s54 offen offset:1024 nt
    s_waitcnt vmcnt(4)
    s_mov_b32 s54, 131072
    buffer_load_dwordx4 v[204:207], v1, s[44:47], s54 offen offset:1536 nt
    s_waitcnt vmcnt(4)
    s_mov_b32 s54, 139264
    buffer_load_dwordx4 v[208:211], v1, s[44:47], s54 offen offset:0 nt
    s_waitcnt vmcnt(4)
    s_mov_b32 s54, 139264
    buffer_load_dwordx4 v[212:215], v1, s[44:47], s54 offen offset:512 nt
    s_waitcnt vmcnt(4)
    s_mov_b32 s54, 139264
    buffer_load_dwordx4 v[216:219], v1, s[44:47], s54 offen offset:1024 nt
    s_waitcnt vmcnt(4)
    s_mov_b32 s54, 139264
    buffer_load_dwordx4 v[220:223], v1, s[44:47], s54 offen offset:1536 nt
    s_waitcnt vmcnt(4)
    s_mov_b32 s54, 147456
    buffer_load_dwordx4 v[224:227], v1, s[44:47], s54 offen offset:0 nt
    s_waitcnt vmcnt(4)
    s_mov_b32 s54, 147456
    buffer_load_dwordx4 v[228:231], v1, s[44:47], s54 offen offset:512 nt
    s_waitcnt vmcnt(4)
    s_mov_b32 s54, 147456
    buffer_load_dwordx4 v[232:235], v1, s[44:47], s54 offen offset:1024 nt
    s_waitcnt vmcnt(4)
    s_mov_b32 s54, 147456
    buffer_load_dwordx4 v[236:239], v1, s[44:47], s54 offen offset:1536 nt
    s_waitcnt vmcnt(4)
    s_mov_b32 s54, 155648
    buffer_load_dwordx4 v[240:243], v1, s[44:47], s54 offen offset:0 nt
    s_waitcnt vmcnt(4)
    s_mov_b32 s54, 155648
    buffer_load_dwordx4 v[244:247], v1, s[44:47], s54 offen offset:512 nt
    s_waitcnt vmcnt(4)
    s_mov_b32 s54, 155648
    buffer_load_dwordx4 v[248:251], v1, s[44:47], s54 offen offset:1024 nt
    v_mov_b32 v12, 0
    v_mov_b32 v13, 2
    ds_max_u32 v12, v13 offset:60
    s_waitcnt vmcnt(4)
    s_mov_b32 s54, 155648
    buffer_load_dwordx4 v[252:255], v1, s[44:47], s54 offen offset:1536 nt
    s_waitcnt vmcnt(4)
    s_mov_b32 s54, 163840
    buffer_load_dwordx4 v[64:67], v1, s[44:47], s54 offen offset:0 nt
    s_waitcnt vmcnt(4)
    s_mov_b32 s54, 163840
    buffer_load_dwordx4 v[68:71], v1, s[44:47], s54 offen offset:512 nt
    s_waitcnt vmcnt(4)
    s_mov_b32 s54, 163840
    buffer_load_dwordx4 v[72:75], v1, s[44:47], s54 offen offset:1024 nt
    s_waitcnt vmcnt(4)
    s_mov_b32 s54, 163840
    buffer_load_dwordx4 v[76:79], v1, s[44:47], s54 offen offset:1536 nt
    s_waitcnt vmcnt(4)
    s_mov_b32 s54, 172032
    buffer_load_dwordx4 v[80:83], v1, s[44:47], s54 offen offset:0 nt
    s_waitcnt vmcnt(4)
    s_mov_b32 s54, 172032
    buffer_load_dwordx4 v[84:87], v1, s[44:47], s54 offen offset:512 nt
    s_waitcnt vmcnt(4)
    s_mov_b32 s54, 172032
    buffer_load_dwordx4 v[88:91], v1, s[44:47], s54 offen offset:1024 nt
    s_waitcnt vmcnt(4)
    s_mov_b32 s54, 172032
    buffer_load_dwordx4 v[92:95], v1, s[44:47], s54 offen offset:1536 nt
    s_waitcnt vmcnt(4)
    s_mov_b32 s54, 180224
    buffer_load_dwordx4 v[96:99], v1, s[44:47], s54 offen offset:0 nt
    s_waitcnt vmcnt(4)
    s_mov_b32 s54, 180224
    buffer_load_dwordx4 v[100:103], v1, s[44:47], s54 offen offset:512 nt
    s_waitcnt vmcnt(4)
    s_mov_b32 s54, 180224
    buffer_load_dwordx4 v[104:107], v1, s[44:47], s54 offen offset:1024 nt
    s_waitcnt vmcnt(4)
    s_mov_b32 s54, 180224
    buffer_load_dwordx4 v[108:111], v1, s[44:47], s54 offen offset:1536 nt
    s_waitcnt vmcnt(4)
    s_mov_b32 s54, 188416
    buffer_load_dwordx4 v[112:115], v1, s[44:47], s54 offen offset:0 nt
    s_waitcnt vmcnt(4)
    s_mov_b32 s54, 188416
    buffer_load_dwordx4 v[116:119], v1, s[44:47], s54 offen offset:512 nt
    s_waitcnt vmcnt(4)
    s_mov_b32 s54, 188416
    buffer_load_dwordx4 v[120:123], v1, s[44:47], s54 offen offset:1024 nt
    s_waitcnt vmcnt(4)
    s_mov_b32 s54, 188416
    buffer_load_dwordx4 v[124:127], v1, s[44:47], s54 offen offset:1536 nt
    v_mov_b32 v12, 0
Llw_1:
    ds_read_b32 v13, v12 offset:8
    s_waitcnt lgkmcnt(0)
    v_readfirstlane_b32 s4, v13
    s_nop 0
    s_cmp_ge_u32 s4, 1
    s_cbranch_scc1 Llwd_2
    s_sleep 1
    s_branch Llw_1
Llwd_2:
    v_and_b32 v12, 3, v0
    v_lshlrev_b32 v12, 6, v12
    v_lshrrev_b32 v13, 4, v0
    v_lshl_add_u32 v12, v13, 4, v12
    ds_read_b128 v[16:19], v12 offset:256
    v_bfe_u32 v13, v0, 2, 2
    s_waitcnt lgkmcnt(0)
    v_cmp_eq_u32 vcc, 0, v13
    s_nop 1
    v_cndmask_b32 v20, 0, v16, vcc
    v_cndmask_b32 v21, 0, v17, vcc
    v_cndmask_b32 v22, 0, v18, vcc
    v_cndmask_b32 v23, 0, v19, vcc
    v_cmp_eq_u32 vcc, 1, v13
    s_nop 1
    v_cndmask_b32 v24, 0, v16, vcc
    v_cndmask_b32 v25, 0, v17, vcc
    v_cndmask_b32 v26, 0, v18, vcc
    v_cndmask_b32 v27, 0, v19, vcc
    v_cmp_eq_u32 vcc, 2, v13
    s_nop 1
    v_cndmask_b32 v28, 0, v16, vcc
    v_cndmask_b32 v29, 0, v17, vcc
    v_cndmask_b32 v30, 0, v18, vcc
    v_cndmask_b32 v31, 0, v19, vcc
    v_cmp_eq_u32 vcc, 3, v13
    s_nop 1
    v_cndmask_b32 v32, 0, v16, vcc
    v_cndmask_b32 v33, 0, v17, vcc
    v_cndmask_b32 v34, 0, v18, vcc
    v_cndmask_b32 v35, 0, v19, vcc
    v_mfma_f32_16x16x32_bf16 v[36:39], v[64:67], v[20:23], 0
    s_waitcnt vmcnt(4)
    s_mov_b32 s54, 262144
    buffer_load_dwordx4 v[64:67], v1, s[44:47], s54 offen offset:0 nt
    v_mfma_f32_16x16x32_bf16 v[36:39], v[68:71], v[24:27], v[36:39]
    s_waitcnt vmcnt(4)
    s_mov_b32 s54, 262144
    buffer_load_dwordx4 v[68:71], v1, s[44:47], s54 offen offset:512 nt
    v_mfma_f32_16x16x32_bf16 v[36:39], v[72:75], v[28:31], v[36:39]
    s_waitcnt vmcnt(4)
    s_mov_b32 s54, 262144
    buffer_load_dwordx4 v[72:75], v1, s[44:47], s54 offen offset:1024 nt
    v_mfma_f32_16x16x32_bf16 v[36:39], v[76:79], v[32:35], v[36:39]
    s_waitcnt vmcnt(4)
    s_mov_b32 s54, 262144
    buffer_load_dwordx4 v[76:79], v1, s[44:47], s54 offen offset:1536 nt
    v_mfma_f32_16x16x32_bf16 v[40:43], v[80:83], v[20:23], 0
    s_waitcnt vmcnt(4)
    s_mov_b32 s54, 270336
    buffer_load_dwordx4 v[80:83], v1, s[44:47], s54 offen offset:0 nt
    s_nop 0
    v_add_f32_dpp v12, v37, v36 quad_perm:[1,1,1,1] row_mask:0xf bank_mask:0xf
    s_nop 1
    v_add_f32_dpp v12, v38, v12 quad_perm:[2,2,2,2] row_mask:0xf bank_mask:0xf
    s_nop 1
    v_add_f32_dpp v12, v39, v12 quad_perm:[3,3,3,3] row_mask:0xf bank_mask:0xf
    v_mfma_f32_16x16x32_bf16 v[40:43], v[84:87], v[24:27], v[40:43]
    v_mfma_f32_16x16x32_bf16 v[40:43], v[88:91], v[28:31], v[40:43]
    v_mfma_f32_16x16x32_bf16 v[40:43], v[92:95], v[32:35], v[40:43]
    v_mfma_f32_16x16x32_bf16 v[44:47], v[96:99], v[20:23], 0
    s_nop 6
    v_add_f32_dpp v13, v42, v41 quad_perm:[2,2,2,2] row_mask:0xf bank_mask:0xf
    s_nop 1
    v_add_f32_dpp v13, v43, v13 quad_perm:[3,3,3,3] row_mask:0xf bank_mask:0xf
    s_nop 1
    v_add_f32_dpp v13, v40, v13 quad_perm:[0,0,0,0] row_mask:0xf bank_mask:0xf
    v_mfma_f32_16x16x32_bf16 v[44:47], v[100:103], v[24:27], v[44:47]
    v_mfma_f32_16x16x32_bf16 v[44:47], v[104:107], v[28:31], v[44:47]
    s_waitcnt vmcnt(4)
    s_mov_b32 s54, 270336
    buffer_load_dwordx4 v[84:87], v1, s[44:47], s54 offen offset:512 nt
    v_mfma_f32_16x16x32_bf16 v[44:47], v[108:111], v[32:35], v[44:47]
    v_mfma_f32_16x16x32_bf16 v[48:51], v[112:115], v[20:23], 0
    s_nop 6
    v_add_f32_dpp v14, v47, v46 quad_perm:[3,3,3,3] row_mask:0xf bank_mask:0xf
    s_nop 1
    v_add_f32_dpp v14, v44, v14 quad_perm:[0,0,0,0] row_mask:0xf bank_mask:0xf
    s_nop 1
    v_add_f32_dpp v14, v45, v14 quad_perm:[1,1,1,1] row_mask:0xf bank_mask:0xf
    v_mfma_f32_16x16x32_bf16 v[48:51], v[116:119], v[24:27], v[48:51]
    v_mfma_f32_16x16x32_bf16 v[48:51], v[120:123], v[28:31], v[48:51]
    v_mfma_f32_16x16x32_bf16 v[48:51], v[124:127], v[32:35], v[48:51]
    s_nop 7
    v_add_f32_dpp v15, v48, v51 quad_perm:[0,0,0,0] row_mask:0xf bank_mask:0xf
    s_nop 1
    v_add_f32_dpp v15, v49, v15 quad_perm:[1,1,1,1] row_mask:0xf bank_mask:0xf
    s_nop 1
    v_add_f32_dpp v15, v50, v15 quad_perm:[2,2,2,2] row_mask:0xf bank_mask:0xf
    v_cndmask_b32 v12, v12, v13, s[62:63]
    v_cndmask_b32 v12, v12, v14, s[64:65]
    v_cndmask_b32 v12, v12, v15, s[66:67]
    v_cvt_pk_bf16_f32 v12, v12, v12
    v_and_b32 v12, 0xffff0000, v12
    v_mul_f32 v12, 0x3db504f3, v12
    v_cvt_pk_bf16_f32 v12, v12, v12
    v_and_b32 v12, 0xffff0000, v12
    ds_write_b32 v5, v12 offset:768
    v_max_f32 v13, v6, v12
    v_sub_f32 v14, v6, v13
    v_sub_f32 v15, v12, v13
    v_mul_f32 v14, 0x3fb8aa3b, v14
    v_mul_f32 v15, 0x3fb8aa3b, v15
    v_exp_f32 v14, v14
    v_exp_f32 v15, v15
    v_mov_b32 v6, v13
    v_fma_f32 v7, v7, v14, v15
    v_mfma_f32_16x16x32_bf16 v[36:39], v[128:131], v[20:23], 0
    s_waitcnt vmcnt(4)
    s_mov_b32 s54, 270336
    buffer_load_dwordx4 v[88:91], v1, s[44:47], s54 offen offset:1024 nt
    v_mfma_f32_16x16x32_bf16 v[36:39], v[132:135], v[24:27], v[36:39]
    v_mfma_f32_16x16x32_bf16 v[36:39], v[136:139], v[28:31], v[36:39]
    v_mfma_f32_16x16x32_bf16 v[36:39], v[140:143], v[32:35], v[36:39]
    v_mfma_f32_16x16x32_bf16 v[40:43], v[144:147], v[20:23], 0
    s_nop 6
    v_add_f32_dpp v12, v37, v36 quad_perm:[1,1,1,1] row_mask:0xf bank_mask:0xf
    s_nop 1
    v_add_f32_dpp v12, v38, v12 quad_perm:[2,2,2,2] row_mask:0xf bank_mask:0xf
    s_nop 1
    v_add_f32_dpp v12, v39, v12 quad_perm:[3,3,3,3] row_mask:0xf bank_mask:0xf
    v_mfma_f32_16x16x32_bf16 v[40:43], v[148:151], v[24:27], v[40:43]
    v_mfma_f32_16x16x32_bf16 v[40:43], v[152:155], v[28:31], v[40:43]
    s_waitcnt vmcnt(4)
    s_mov_b32 s54, 270336
    buffer_load_dwordx4 v[92:95], v1, s[44:47], s54 offen offset:1536 nt
    v_mfma_f32_16x16x32_bf16 v[40:43], v[156:159], v[32:35], v[40:43]
    v_mfma_f32_16x16x32_bf16 v[44:47], v[160:163], v[20:23], 0
    s_nop 6
    v_add_f32_dpp v13, v42, v41 quad_perm:[2,2,2,2] row_mask:0xf bank_mask:0xf
    s_nop 1
    v_add_f32_dpp v13, v43, v13 quad_perm:[3,3,3,3] row_mask:0xf bank_mask:0xf
    s_nop 1
    v_add_f32_dpp v13, v40, v13 quad_perm:[0,0,0,0] row_mask:0xf bank_mask:0xf
    v_mfma_f32_16x16x32_bf16 v[44:47], v[164:167], v[24:27], v[44:47]
    v_mfma_f32_16x16x32_bf16 v[44:47], v[168:171], v[28:31], v[44:47]
    v_mfma_f32_16x16x32_bf16 v[44:47], v[172:175], v[32:35], v[44:47]
    v_mfma_f32_16x16x32_bf16 v[48:51], v[176:179], v[20:23], 0
    s_waitcnt vmcnt(4)
    s_mov_b32 s54, 278528
    buffer_load_dwordx4 v[96:99], v1, s[44:47], s54 offen offset:0 nt
    s_nop 3
    v_add_f32_dpp v14, v47, v46 quad_perm:[3,3,3,3] row_mask:0xf bank_mask:0xf
    s_nop 1
    v_add_f32_dpp v14, v44, v14 quad_perm:[0,0,0,0] row_mask:0xf bank_mask:0xf
    s_nop 1
    v_add_f32_dpp v14, v45, v14 quad_perm:[1,1,1,1] row_mask:0xf bank_mask:0xf
    v_mfma_f32_16x16x32_bf16 v[48:51], v[180:183], v[24:27], v[48:51]
    v_mfma_f32_16x16x32_bf16 v[48:51], v[184:187], v[28:31], v[48:51]
    v_mfma_f32_16x16x32_bf16 v[48:51], v[188:191], v[32:35], v[48:51]
    s_nop 7
    v_add_f32_dpp v15, v48, v51 quad_perm:[0,0,0,0] row_mask:0xf bank_mask:0xf
    s_nop 1
    v_add_f32_dpp v15, v49, v15 quad_perm:[1,1,1,1] row_mask:0xf bank_mask:0xf
    s_nop 1
    v_add_f32_dpp v15, v50, v15 quad_perm:[2,2,2,2] row_mask:0xf bank_mask:0xf
    v_cndmask_b32 v12, v12, v13, s[62:63]
    v_cndmask_b32 v12, v12, v14, s[64:65]
    v_cndmask_b32 v12, v12, v15, s[66:67]
    v_cvt_pk_bf16_f32 v12, v12, v12
    v_and_b32 v12, 0xffff0000, v12
    v_mul_f32 v12, 0x3db504f3, v12
    v_cvt_pk_bf16_f32 v12, v12, v12
    v_and_b32 v12, 0xffff0000, v12
    ds_write_b32 v5, v12 offset:0
    v_max_f32 v13, v6, v12
    v_sub_f32 v14, v6, v13
    v_sub_f32 v15, v12, v13
    v_mul_f32 v14, 0x3fb8aa3b, v14
    v_mul_f32 v15, 0x3fb8aa3b, v15
    v_exp_f32 v14, v14
    v_exp_f32 v15, v15
    v_mov_b32 v6, v13
    v_fma_f32 v7, v7, v14, v15
    v_lshl_add_u32 v16, v0, 4, s10
    ds_read_b128 v[128:131], v16 offset:0
    ds_read_b128 v[132:135], v16 offset:1024
    ds_read_b128 v[136:139], v16 offset:2048
    ds_read_b128 v[140:143], v16 offset:3072
    ds_read_b128 v[144:147], v16 offset:4096
    ds_read_b128 v[148:151], v16 offset:5120
    ds_read_b128 v[152:155], v16 offset:6144
    ds_read_b128 v[156:159], v16 offset:7168
    s_waitcnt lgkmcnt(0)
    ds_read_b128 v[160:163], v16 offset:8192
    ds_read_b128 v[164:167], v16 offset:9216
    ds_read_b128 v[168:171], v16 offset:10240
    ds_read_b128 v[172:175], v16 offset:11264
    ds_read_b128 v[176:179], v16 offset:12288
    ds_read_b128 v[180:183], v16 offset:13312
    ds_read_b128 v[184:187], v16 offset:14336
    ds_read_b128 v[188:191], v16 offset:15360
    v_mfma_f32_16x16x32_bf16 v[36:39], v[192:195], v[20:23], 0
    v_mfma_f32_16x16x32_bf16 v[36:39], v[196:199], v[24:27], v[36:39]
    v_mfma_f32_16x16x32_bf16 v[36:39], v[200:203], v[28:31], v[36:39]
    s_waitcnt vmcnt(4)
    s_mov_b32 s54, 278528
    buffer_load_dwordx4 v[100:103], v1, s[44:47], s54 offen offset:512 nt
    v_mfma_f32_16x16x32_bf16 v[36:39], v[204:207], v[32:35], v[36:39]
    v_mfma_f32_16x16x32_bf16 v[40:43], v[208:211], v[20:23], 0
    s_nop 6
    v_add_f32_dpp v12, v37, v36 quad_perm:[1,1,1,1] row_mask:0xf bank_mask:0xf
    s_nop 1
    v_add_f32_dpp v12, v38, v12 quad_perm:[2,2,2,2] row_mask:0xf bank_mask:0xf
    s_nop 1
    v_add_f32_dpp v12, v39, v12 quad_perm:[3,3,3,3] row_mask:0xf bank_mask:0xf
    v_mfma_f32_16x16x32_bf16 v[40:43], v[212:215], v[24:27], v[40:43]
    v_mfma_f32_16x16x32_bf16 v[40:43], v[216:219], v[28:31], v[40:43]
    v_mfma_f32_16x16x32_bf16 v[40:43], v[220:223], v[32:35], v[40:43]
    v_mfma_f32_16x16x32_bf16 v[44:47], v[224:227], v[20:23], 0
    s_waitcnt vmcnt(4)
    s_mov_b32 s54, 278528
    buffer_load_dwordx4 v[104:107], v1, s[44:47], s54 offen offset:1024 nt
    s_nop 3
    v_add_f32_dpp v13, v42, v41 quad_perm:[2,2,2,2] row_mask:0xf bank_mask:0xf
    s_nop 1
    v_add_f32_dpp v13, v43, v13 quad_perm:[3,3,3,3] row_mask:0xf bank_mask:0xf
    s_nop 1
    v_add_f32_dpp v13, v40, v13 quad_perm:[0,0,0,0] row_mask:0xf bank_mask:0xf
    v_mfma_f32_16x16x32_bf16 v[44:47], v[228:231], v[24:27], v[44:47]
    v_mfma_f32_16x16x32_bf16 v[44:47], v[232:235], v[28:31], v[44:47]
    v_mfma_f32_16x16x32_bf16 v[44:47], v[236:239], v[32:35], v[44:47]
    v_mfma_f32_16x16x32_bf16 v[48:51], v[240:243], v[20:23], 0
    s_nop 6
    v_add_f32_dpp v14, v47, v46 quad_perm:[3,3,3,3] row_mask:0xf bank_mask:0xf
    s_nop 1
    v_add_f32_dpp v14, v44, v14 quad_perm:[0,0,0,0] row_mask:0xf bank_mask:0xf
    s_nop 1
    v_add_f32_dpp v14, v45, v14 quad_perm:[1,1,1,1] row_mask:0xf bank_mask:0xf
    v_mfma_f32_16x16x32_bf16 v[48:51], v[244:247], v[24:27], v[48:51]
    v_mfma_f32_16x16x32_bf16 v[48:51], v[248:251], v[28:31], v[48:51]
    s_waitcnt vmcnt(4)
    s_mov_b32 s54, 278528
    buffer_load_dwordx4 v[108:111], v1, s[44:47], s54 offen offset:1536 nt
    v_mfma_f32_16x16x32_bf16 v[48:51], v[252:255], v[32:35], v[48:51]
    s_nop 7
    v_add_f32_dpp v15, v48, v51 quad_perm:[0,0,0,0] row_mask:0xf bank_mask:0xf
    s_nop 1
    v_add_f32_dpp v15, v49, v15 quad_perm:[1,1,1,1] row_mask:0xf bank_mask:0xf
    s_nop 1
    v_add_f32_dpp v15, v50, v15 quad_perm:[2,2,2,2] row_mask:0xf bank_mask:0xf
    v_cndmask_b32 v12, v12, v13, s[62:63]
    v_cndmask_b32 v12, v12, v14, s[64:65]
    v_cndmask_b32 v12, v12, v15, s[66:67]
    v_cvt_pk_bf16_f32 v12, v12, v12
    v_and_b32 v12, 0xffff0000, v12
    v_mul_f32 v12, 0x3db504f3, v12
    v_cvt_pk_bf16_f32 v12, v12, v12
    v_and_b32 v12, 0xffff0000, v12
    ds_write_b32 v5, v12 offset:512
    v_max_f32 v13, v6, v12
    v_sub_f32 v14, v6, v13
    v_sub_f32 v15, v12, v13
    v_mul_f32 v14, 0x3fb8aa3b, v14
    v_mul_f32 v15, 0x3fb8aa3b, v15
    v_exp_f32 v14, v14
    v_exp_f32 v15, v15
    v_mov_b32 v6, v13
    v_fma_f32 v7, v7, v14, v15
    s_mov_b64 exec, 1
    v_mov_b32 v16, 0
    v_mov_b32 v17, 1
    s_waitcnt lgkmcnt(0)
    ds_add_u32 v16, v17 offset:20
    s_mov_b64 exec, -1
    v_mfma_f32_16x16x32_bf16 v[36:39], v[128:131], v[20:23], 0
    v_mfma_f32_16x16x32_bf16 v[36:39], v[132:135], v[24:27], v[36:39]
    v_mfma_f32_16x16x32_bf16 v[36:39], v[136:139], v[28:31], v[36:39]
    v_mfma_f32_16x16x32_bf16 v[36:39], v[140:143], v[32:35], v[36:39]
    v_mfma_f32_16x16x32_bf16 v[40:43], v[144:147], v[20:23], 0
    s_waitcnt vmcnt(4)
    s_mov_b32 s54, 286720
    buffer_load_dwordx4 v[112:115], v1, s[44:47], s54 offen offset:0 nt
    s_nop 3
    v_add_f32_dpp v12, v37, v36 quad_perm:[1,1,1,1] row_mask:0xf bank_mask:0xf
    s_nop 1
    v_add_f32_dpp v12, v38, v12 quad_perm:[2,2,2,2] row_mask:0xf bank_mask:0xf
    s_nop 1
    v_add_f32_dpp v12, v39, v12 quad_perm:[3,3,3,3] row_mask:0xf bank_mask:0xf
    v_mfma_f32_16x16x32_bf16 v[40:43], v[148:151], v[24:27], v[40:43]
    v_mfma_f32_16x16x32_bf16 v[40:43], v[152:155], v[28:31], v[40:43]
    v_mfma_f32_16x16x32_bf16 v[40:43], v[156:159], v[32:35], v[40:43]
    v_mfma_f32_16x16x32_bf16 v[44:47], v[160:163], v[20:23], 0
    s_nop 6
    v_add_f32_dpp v13, v42, v41 quad_perm:[2,2,2,2] row_mask:0xf bank_mask:0xf
    s_nop 1
    v_add_f32_dpp v13, v43, v13 quad_perm:[3,3,3,3] row_mask:0xf bank_mask:0xf
    s_nop 1
    v_add_f32_dpp v13, v40, v13 quad_perm:[0,0,0,0] row_mask:0xf bank_mask:0xf
    v_mfma_f32_16x16x32_bf16 v[44:47], v[164:167], v[24:27], v[44:47]
    v_mfma_f32_16x16x32_bf16 v[44:47], v[168:171], v[28:31], v[44:47]
    s_waitcnt vmcnt(4)
    s_mov_b32 s54, 286720
    buffer_load_dwordx4 v[116:119], v1, s[44:47], s54 offen offset:512 nt
    v_mfma_f32_16x16x32_bf16 v[44:47], v[172:175], v[32:35], v[44:47]
    v_mfma_f32_16x16x32_bf16 v[48:51], v[176:179], v[20:23], 0
    s_nop 6
    v_add_f32_dpp v14, v47, v46 quad_perm:[3,3,3,3] row_mask:0xf bank_mask:0xf
    s_nop 1
    v_add_f32_dpp v14, v44, v14 quad_perm:[0,0,0,0] row_mask:0xf bank_mask:0xf
    s_nop 1
    v_add_f32_dpp v14, v45, v14 quad_perm:[1,1,1,1] row_mask:0xf bank_mask:0xf
    v_mfma_f32_16x16x32_bf16 v[48:51], v[180:183], v[24:27], v[48:51]
    v_mfma_f32_16x16x32_bf16 v[48:51], v[184:187], v[28:31], v[48:51]
    v_mfma_f32_16x16x32_bf16 v[48:51], v[188:191], v[32:35], v[48:51]
    s_nop 7
    v_add_f32_dpp v15, v48, v51 quad_perm:[0,0,0,0] row_mask:0xf bank_mask:0xf
    s_nop 1
    v_add_f32_dpp v15, v49, v15 quad_perm:[1,1,1,1] row_mask:0xf bank_mask:0xf
    s_nop 1
    v_add_f32_dpp v15, v50, v15 quad_perm:[2,2,2,2] row_mask:0xf bank_mask:0xf
    v_cndmask_b32 v12, v12, v13, s[62:63]
    v_cndmask_b32 v12, v12, v14, s[64:65]
    v_cndmask_b32 v12, v12, v15, s[66:67]
    v_cvt_pk_bf16_f32 v12, v12, v12
    v_and_b32 v12, 0xffff0000, v12
    v_mul_f32 v12, 0x3db504f3, v12
    v_cvt_pk_bf16_f32 v12, v12, v12
    v_and_b32 v12, 0xffff0000, v12
    ds_write_b32 v5, v12 offset:256
    v_max_f32 v13, v6, v12
    v_sub_f32 v14, v6, v13
    v_sub_f32 v15, v12, v13
    v_mul_f32 v14, 0x3fb8aa3b, v14
    v_mul_f32 v15, 0x3fb8aa3b, v15
    v_exp_f32 v14, v14
    v_exp_f32 v15, v15
    v_mov_b32 v6, v13
    v_fma_f32 v7, v7, v14, v15
    s_lshr_b32 s4, s68, 1
    s_and_b32 s5, s68, 1
    s_mul_i32 s6, s4, 28
    s_lshl_b32 s7, s5, 4
    s_add_u32 s6, s6, s7
    s_add_u32 s6, s6, s69
    s_add_u32 s6, s6, 56
    s_mul_i32 s4, s4, 12
    s_lshl_b32 s7, s5, 3
    s_add_u32 s4, s4, s7
    s_add_u32 s4, s4, s69
    s_add_u32 s4, s4, 152
    s_lshl_b32 s5, s5, 2
    s_add_u32 s5, s5, s69
    s_cmp_lt_u32 s5, 24
    s_cselect_b32 s26, s6, s4
    s_cmp_lt_u32 s2, 64
    s_cselect_b32 s26, s2, s26
    s_cmp_ge_u32 s2, 224
    s_cselect_b32 s26, s2, s26
    s_add_u32 s14, s14, 0x9e3779b1
    s_bfe_u32 s98, s14, 0x80000
    s_bfe_u32 s99, s14, 0x80008
    s_bfe_u32 s100, s14, 0x80010
    s_bfe_u32 s101, s14, 0x80018
    s_lshl_b32 s5, s59, 21
    s_add_u32 s6, s20, s5
    s_addc_u32 s7, s21, 0
    s_mul_i32 s8, s58, 127
    s_lshl_b32 s4, s58, 1
    s_sub_u32 s12, 1, s4
    s_lshl_b32 s4, s3, 13
    s_lshl_b32 s5, s8, 6
    s_add_u32 s4, s4, s5
    s_add_u32 s4, s4, 53248
    v_and_b32 v12, 3, v0
    v_lshl_add_u32 v56, v12, 2, s4
    v_and_b32 v12, 48, v0
    v_add_u32 v56, v12, v56
    s_lshl_b32 s4, s12, 6
    v_mov_b32 v57, s4
    v_mov_b32 v3, 0
    v_mov_b32 v10, 0
    v_mov_b32 v17, 1
    s_lshl_b32 s4, s3, 9
    v_lshl_add_u32 v59, v0, 3, s4
    s_lshl_b32 s4, s3, 2
    v_mov_b32 v11, s4
    v_and_b32 v12, 1, v0
    v_lshlrev_b32 v12, 4, v12
    v_mov_b32 v13, 0xffff
    v_lshlrev_b32 v12, v12, v13
    v_bfe_u32 v13, v0, 1, 3
    v_cmp_eq_u32 vcc, 0, v13
    s_nop 1
    v_cndmask_b32 v52, 0, v12, vcc
    v_mov_b32 v60, 0
    v_cmp_eq_u32 vcc, 1, v13
    s_nop 1
    v_cndmask_b32 v53, 0, v12, vcc
    v_mov_b32 v61, 0
    v_cmp_eq_u32 vcc, 2, v13
    s_nop 1
    v_cndmask_b32 v54, 0, v12, vcc
    v_mov_b32 v62, 0
    v_cmp_eq_u32 vcc, 3, v13
    s_nop 1
    v_cndmask_b32 v55, 0, v12, vcc
    v_mov_b32 v63, 0
    s_mov_b32 s9, 0x3fb8aa3b
    s_mov_b32 s13, 0xffff
    v_and_b32 v16, 15, v0
    v_lshlrev_b32 v16, 4, v16
    v_bfe_u32 v13, v0, 4, 1
    v_lshl_add_u32 v16, v13, 3, v16
    s_lshl_b32 s4, s3, 8
    v_add_u32 v16, s4, v16
    v_lshrrev_b32 v236, 4, v0
    v_bfe_u32 v237, v0, 2, 2
    v_lshlrev_b32 v238, 13, v236
    v_lshl_add_u32 v238, v237, 10, v238
    v_and_b32 v239, 3, v0
    v_lshl_add_u32 v238, v239, 3, v238
    v_bfe_u32 v237, v0, 2, 3
    s_and_b32 s4, s61, 1
    s_lshl_b32 s4, s4, 2
    v_xor_b32 v237, s4, v237
    s_lshr_b32 s4, s61, 1
    s_lshl_b32 s4, s4, 8
    s_add_u32 s4, s4, 86016
    v_add_u32 v238, s4, v238
    v_xor_b32 v232, 0, v237
    v_lshl_add_u32 v232, v232, 5, v238
    v_xor_b32 v233, 1, v237
    v_lshl_add_u32 v233, v233, 5, v238
    v_xor_b32 v234, 2, v237
    v_lshl_add_u32 v234, v234, 5, v238
    v_xor_b32 v235, 3, v237
    v_lshl_add_u32 v235, v235, 5, v238
    v_lshlrev_b32 v226, 8, v239
    v_lshl_add_u32 v226, v236, 4, v226
    s_xor_b32 s4, s57, 0
    s_and_b32 s4, s4, 1
    s_lshl_b32 s4, s4, 2
    s_xor_b32 s4, s4, s3
    s_xor_b32 s4, s4, 4
    s_lshl_b32 s4, s4, 1
    s_lshl_b32 s5, s56, 4
    s_add_u32 s4, s4, s5
    s_lshl_b32 s4, s4, 13
    s_and_b32 s5, s2, 63
    s_lshl_b32 s5, s5, 7
    s_add_u32 s4, s4, s5
    s_add_u32 s4, s4, 524288
    v_lshrrev_b32 v227, 5, v0
    v_lshl_add_u32 v227, v227, 13, s4
    v_and_b32 v228, 31, v0
    v_lshl_add_u32 v227, v228, 2, v227
    v_lshlrev_b32 v228, 3, v239
    v_lshrrev_b32 v228, v228, s14
    v_mov_b32 v229, 0xff
    s_waitcnt vmcnt(13)
    v_mfma_f32_16x16x32_bf16 v[36:39], v[64:67], v[20:23], 0
    s_waitcnt vmcnt(12)
    v_mfma_f32_16x16x32_bf16 v[36:39], v[68:71], v[24:27], v[36:39]
    s_waitcnt vmcnt(11)
    v_mfma_f32_16x16x32_bf16 v[36:39], v[72:75], v[28:31], v[36:39]
    s_waitcnt vmcnt(10)
    v_mfma_f32_16x16x32_bf16 v[36:39], v[76:79], v[32:35], v[36:39]
    s_waitcnt vmcnt(9)
    v_mfma_f32_16x16x32_bf16 v[40:43], v[80:83], v[20:23], 0
    s_nop 5
    v_add_f32_dpp v12, v37, v36 quad_perm:[1,1,1,1] row_mask:0xf bank_mask:0xf
    s_nop 1
    v_add_f32_dpp v12, v38, v12 quad_perm:[2,2,2,2] row_mask:0xf bank_mask:0xf
    s_nop 1
    v_add_f32_dpp v12, v39, v12 quad_perm:[3,3,3,3] row_mask:0xf bank_mask:0xf
    s_waitcnt vmcnt(8)
    v_mfma_f32_16x16x32_bf16 v[40:43], v[84:87], v[24:27], v[40:43]
    s_waitcnt vmcnt(4)
    s_mov_b32 s54, 286720
    buffer_load_dwordx4 v[120:123], v1, s[44:47], s54 offen offset:1024 nt
    v_mfma_f32_16x16x32_bf16 v[40:43], v[88:91], v[28:31], v[40:43]
    s_waitcnt vmcnt(4)
    s_mov_b32 s54, 286720
    buffer_load_dwordx4 v[124:127], v1, s[44:47], s54 offen offset:1536 nt
    v_mfma_f32_16x16x32_bf16 v[40:43], v[92:95], v[32:35], v[40:43]
    s_waitcnt vmcnt(4)
    s_mov_b32 s54, 294912
    buffer_load_dwordx4 v[64:67], v1, s[44:47], s54 offen offset:0 nt
    v_mfma_f32_16x16x32_bf16 v[44:47], v[96:99], v[20:23], 0
    s_nop 3
    v_add_f32_dpp v13, v42, v41 quad_perm:[2,2,2,2] row_mask:0xf bank_mask:0xf
    s_nop 1
    v_add_f32_dpp v13, v43, v13 quad_perm:[3,3,3,3] row_mask:0xf bank_mask:0xf
    s_nop 1
    v_add_f32_dpp v13, v40, v13 quad_perm:[0,0,0,0] row_mask:0xf bank_mask:0xf
    s_waitcnt vmcnt(4)
    s_mov_b32 s54, 294912
    buffer_load_dwordx4 v[68:71], v1, s[44:47], s54 offen offset:512 nt
    v_mfma_f32_16x16x32_bf16 v[44:47], v[100:103], v[24:27], v[44:47]
    s_waitcnt vmcnt(4)
    s_mov_b32 s54, 294912
    buffer_load_dwordx4 v[72:75], v1, s[44:47], s54 offen offset:1024 nt
    v_mfma_f32_16x16x32_bf16 v[44:47], v[104:107], v[28:31], v[44:47]
    s_waitcnt vmcnt(4)
    s_mov_b32 s54, 294912
    buffer_load_dwordx4 v[76:79], v1, s[44:47], s54 offen offset:1536 nt
    v_mfma_f32_16x16x32_bf16 v[44:47], v[108:111], v[32:35], v[44:47]
    s_waitcnt vmcnt(4)
    s_mov_b32 s54, 303104
    buffer_load_dwordx4 v[80:83], v1, s[44:47], s54 offen offset:0 nt
    v_mfma_f32_16x16x32_bf16 v[48:51], v[112:115], v[20:23], 0
    s_nop 3
    v_add_f32_dpp v14, v47, v46 quad_perm:[3,3,3,3] row_mask:0xf bank_mask:0xf
    s_nop 1
    v_add_f32_dpp v14, v44, v14 quad_perm:[0,0,0,0] row_mask:0xf bank_mask:0xf
    s_nop 1
    v_add_f32_dpp v14, v45, v14 quad_perm:[1,1,1,1] row_mask:0xf bank_mask:0xf
    s_waitcnt vmcnt(4)
    s_mov_b32 s54, 303104
    buffer_load_dwordx4 v[84:87], v1, s[44:47], s54 offen offset:512 nt
    v_mfma_f32_16x16x32_bf16 v[48:51], v[116:119], v[24:27], v[48:51]
    s_waitcnt vmcnt(4)
    s_mov_b32 s54, 303104
    buffer_load_dwordx4 v[88:91], v1, s[44:47], s54 offen offset:1024 nt
    v_mfma_f32_16x16x32_bf16 v[48:51], v[120:123], v[28:31], v[48:51]
    s_waitcnt vmcnt(4)
    s_mov_b32 s54, 303104
    buffer_load_dwordx4 v[92:95], v1, s[44:47], s54 offen offset:1536 nt
    v_mfma_f32_16x16x32_bf16 v[48:51], v[124:127], v[32:35], v[48:51]
    s_nop 7
    v_add_f32_dpp v15, v48, v51 quad_perm:[0,0,0,0] row_mask:0xf bank_mask:0xf
    s_nop 1
    v_add_f32_dpp v15, v49, v15 quad_perm:[1,1,1,1] row_mask:0xf bank_mask:0xf
    s_nop 1
    v_add_f32_dpp v15, v50, v15 quad_perm:[2,2,2,2] row_mask:0xf bank_mask:0xf
    v_cndmask_b32 v12, v12, v13, s[62:63]
    v_cndmask_b32 v12, v12, v14, s[64:65]
    v_cndmask_b32 v12, v12, v15, s[66:67]
    v_cvt_pk_bf16_f32 v12, v12, v12
    v_and_b32 v12, 0xffff0000, v12
    v_mul_f32 v12, 0x3db504f3, v12
    v_cvt_pk_bf16_f32 v12, v12, v12
    v_and_b32 v12, 0xffff0000, v12
    ds_write_b32 v5, v12 offset:1024
    v_max_f32 v13, v6, v12
    v_sub_f32 v14, v6, v13
    v_sub_f32 v15, v12, v13
    v_mul_f32 v14, 0x3fb8aa3b, v14
    v_mul_f32 v15, 0x3fb8aa3b, v15
    v_exp_f32 v14, v14
    v_exp_f32 v15, v15
    v_mov_b32 v6, v13
    v_fma_f32 v7, v7, v14, v15
    s_mov_b32 s53, 294912
    s_mov_b32 s55, 20
    v_add_u32 v5, 1280, v5
L_kloop:
    s_mov_b32 s52, s53
    s_add_u32 s55, s55, 4
    s_bfe_u32 s53, s55, 0x30000
    s_lshl_b32 s53, s53, 13
    s_bfe_u32 s4, s55, 0x40003
    s_lshl_b32 s4, s4, 17
    s_or_b32 s53, s53, s4
    s_add_u32 s11, s53, 8192
    s_cmp_lg_u32 s55, 64
    s_cbranch_scc1 L_knosw
    s_mov_b32 s48, s6
    s_mov_b32 s49, s7
    s_mov_b32 s50, 0x200000
    v_mov_b32 v4, v2
    s_bfe_u32 s53, s8, 0x30000
    s_lshl_b32 s53, s53, 13
    s_bfe_u32 s4, s8, 0x40003
    s_lshl_b32 s4, s4, 17
    s_or_b32 s53, s53, s4
    s_add_u32 s5, s8, s12
    s_bfe_u32 s11, s5, 0x30000
    s_lshl_b32 s11, s11, 13
    s_bfe_u32 s4, s5, 0x40003
    s_lshl_b32 s4, s4, 17
    s_or_b32 s11, s11, s4
L_knosw:
    s_waitcnt vmcnt(4)
    s_add_u32 s54, s52, 16384
    buffer_load_dwordx4 v[96:99], v1, s[44:47], s54 offen offset:0 nt
    v_mfma_f32_16x16x32_bf16 v[36:39], v[64:67], v[20:23], 0
    s_waitcnt vmcnt(4)
    s_add_u32 s54, s52, 16384
    buffer_load_dwordx4 v[100:103], v1, s[44:47], s54 offen offset:512 nt
    v_mfma_f32_16x16x32_bf16 v[36:39], v[68:71], v[24:27], v[36:39]
    s_waitcnt vmcnt(4)
    s_add_u32 s54, s52, 16384
    buffer_load_dwordx4 v[104:107], v1, s[44:47], s54 offen offset:1024 nt
    v_mfma_f32_16x16x32_bf16 v[36:39], v[72:75], v[28:31], v[36:39]
    s_waitcnt vmcnt(4)
    s_add_u32 s54, s52, 16384
    buffer_load_dwordx4 v[108:111], v1, s[44:47], s54 offen offset:1536 nt
    v_mfma_f32_16x16x32_bf16 v[36:39], v[76:79], v[32:35], v[36:39]
    s_waitcnt vmcnt(4)
    s_add_u32 s54, s52, 24576
    buffer_load_dwordx4 v[112:115], v1, s[44:47], s54 offen offset:0 nt
    v_mfma_f32_16x16x32_bf16 v[40:43], v[80:83], v[20:23], 0
    s_nop 3
    v_add_f32_dpp v12, v37, v36 quad_perm:[1,1,1,1] row_mask:0xf bank_mask:0xf
    s_nop 1
    v_add_f32_dpp v12, v38, v12 quad_perm:[2,2,2,2] row_mask:0xf bank_mask:0xf
    s_nop 1
    v_add_f32_dpp v12, v39, v12 quad_perm:[3,3,3,3] row_mask:0xf bank_mask:0xf
    s_waitcnt vmcnt(4)
    s_add_u32 s54, s52, 24576
    buffer_load_dwordx4 v[116:119], v1, s[44:47], s54 offen offset:512 nt
    v_mfma_f32_16x16x32_bf16 v[40:43], v[84:87], v[24:27], v[40:43]
    s_waitcnt vmcnt(4)
    s_add_u32 s54, s52, 24576
    buffer_load_dwordx4 v[120:123], v1, s[44:47], s54 offen offset:1024 nt
    v_mfma_f32_16x16x32_bf16 v[40:43], v[88:91], v[28:31], v[40:43]
    s_waitcnt vmcnt(4)
    s_add_u32 s54, s52, 24576
    buffer_load_dwordx4 v[124:127], v1, s[44:47], s54 offen offset:1536 nt
    v_mfma_f32_16x16x32_bf16 v[40:43], v[92:95], v[32:35], v[40:43]
    s_waitcnt vmcnt(4)
    buffer_load_dwordx4 v[64:67], v4, s[48:51], s53 offen offset:0 nt
    v_mfma_f32_16x16x32_bf16 v[44:47], v[96:99], v[20:23], 0
    s_nop 4
    v_add_f32_dpp v13, v42, v41 quad_perm:[2,2,2,2] row_mask:0xf bank_mask:0xf
    s_nop 1
    v_add_f32_dpp v13, v43, v13 quad_perm:[3,3,3,3] row_mask:0xf bank_mask:0xf
    s_nop 1
    v_add_f32_dpp v13, v40, v13 quad_perm:[0,0,0,0] row_mask:0xf bank_mask:0xf
    s_waitcnt vmcnt(4)
    buffer_load_dwordx4 v[68:71], v4, s[48:51], s53 offen offset:512 nt
    v_mfma_f32_16x16x32_bf16 v[44:47], v[100:103], v[24:27], v[44:47]
    s_waitcnt vmcnt(4)
    buffer_load_dwordx4 v[72:75], v4, s[48:51], s53 offen offset:1024 nt
    v_mfma_f32_16x16x32_bf16 v[44:47], v[104:107], v[28:31], v[44:47]
    s_waitcnt vmcnt(4)
    buffer_load_dwordx4 v[76:79], v4, s[48:51], s53 offen offset:1536 nt
    v_mfma_f32_16x16x32_bf16 v[44:47], v[108:111], v[32:35], v[44:47]
    s_waitcnt vmcnt(4)
    buffer_load_dwordx4 v[80:83], v4, s[48:51], s11 offen offset:0 nt
    v_mfma_f32_16x16x32_bf16 v[48:51], v[112:115], v[20:23], 0
    s_nop 4
    v_add_f32_dpp v14, v47, v46 quad_perm:[3,3,3,3] row_mask:0xf bank_mask:0xf
    s_nop 1
    v_add_f32_dpp v14, v44, v14 quad_perm:[0,0,0,0] row_mask:0xf bank_mask:0xf
    s_nop 1
    v_add_f32_dpp v14, v45, v14 quad_perm:[1,1,1,1] row_mask:0xf bank_mask:0xf
    s_waitcnt vmcnt(4)
    buffer_load_dwordx4 v[84:87], v4, s[48:51], s11 offen offset:512 nt
    v_mfma_f32_16x16x32_bf16 v[48:51], v[116:119], v[24:27], v[48:51]
    s_waitcnt vmcnt(4)
    buffer_load_dwordx4 v[88:91], v4, s[48:51], s11 offen offset:1024 nt
    v_mfma_f32_16x16x32_bf16 v[48:51], v[120:123], v[28:31], v[48:51]
    s_waitcnt vmcnt(4)
    buffer_load_dwordx4 v[92:95], v4, s[48:51], s11 offen offset:1536 nt
    v_mfma_f32_16x16x32_bf16 v[48:51], v[124:127], v[32:35], v[48:51]
    s_nop 7
    v_add_f32_dpp v15, v48, v51 quad_perm:[0,0,0,0] row_mask:0xf bank_mask:0xf
    s_nop 1
    v_add_f32_dpp v15, v49, v15 quad_perm:[1,1,1,1] row_mask:0xf bank_mask:0xf
    s_nop 1
    v_add_f32_dpp v15, v50, v15 quad_perm:[2,2,2,2] row_mask:0xf bank_mask:0xf
    v_cndmask_b32 v12, v12, v13, s[62:63]
    v_cndmask_b32 v12, v12, v14, s[64:65]
    v_cndmask_b32 v12, v12, v15, s[66:67]
    v_cvt_pk_bf16_f32 v12, v12, v12
    v_and_b32 v12, 0xffff0000, v12
    v_mul_f32 v12, 0x3db504f3, v12
    v_cvt_pk_bf16_f32 v12, v12, v12
    v_and_b32 v12, 0xffff0000, v12
    ds_write_b32 v5, v12 offset:0
    v_max_f32 v13, v6, v12
    v_sub_f32 v14, v6, v13
    v_sub_f32 v15, v12, v13
    v_mul_f32 v14, 0x3fb8aa3b, v14
    v_mul_f32 v15, 0x3fb8aa3b, v15
    v_exp_f32 v14, v14
    v_exp_f32 v15, v15
    v_mov_b32 v6, v13
    v_fma_f32 v7, v7, v14, v15
    v_add_u32 v5, 256, v5
    s_cmp_lg_u32 s55, 64
    s_cbranch_scc1 L_kloop
    s_add_u32 s52, s8, s12
    s_add_u32 s52, s52, s12
    s_mov_b32 s55, 0
    ds_write_b64 v59, v[6:7] offset:12288
    v_mov_b32 v5, v56
    v_mov_b32 v4, 0
    ds_read_b32 v8, v56
    s_mov_b64 exec, 1
    ds_add_u32 v3, v17 offset:12
    s_mov_b64 exec, -1
    v_max_f32_dpp v12, v6, v6 row_ror:8 row_mask:0xf bank_mask:0xf
    s_nop 1
    v_max_f32_dpp v12, v12, v12 row_ror:4 row_mask:0xf bank_mask:0xf
    s_nop 1
    v_max_f32_dpp v12, v12, v12 row_ror:2 row_mask:0xf bank_mask:0xf
    s_nop 1
    v_max_f32_dpp v12, v12, v12 row_ror:1 row_mask:0xf bank_mask:0xf
    v_mov_b32 v13, v12
    s_nop 1
    v_permlane16_swap_b32 v12, v13
    v_max_f32 v12, v12, v13
    v_mov_b32 v13, v12
    s_nop 1
    v_permlane32_swap_b32 v12, v13
    v_max_f32 v18, v12, v13
L_v1:
    s_waitcnt lgkmcnt(0)
    v_sub_f32 v9, v8, v18
    v_fma_f32 v9, v9, s9, v10
    v_add_u32 v5, v57, v5
    v_exp_f32 v9, v9
    v_mov_b32 v12, s55
    ds_write_b32 v11, v12 offset:32
    v_readfirstlane_b32 s4, v4
    s_nop 0
    s_lshr_b32 s5, s4, 24
    s_add_u32 s5, s5, s55
    s_lshl_b32 s5, s5, 9
    s_or_b32 s5, s5, s4
    s_bitcmp1_b32 s5, 16
    s_cselect_b64 vcc, -1, 0
    s_bfe_u32 s53, s52, 0x30000
    s_lshl_b32 s53, s53, 13
    s_bfe_u32 s4, s52, 0x40003
    s_lshl_b32 s4, s4, 17
    s_or_b32 s53, s53, s4
    s_add_u32 s52, s52, s12
Lgo_5:
    v_cvt_pk_bf16_f32 v9, v9, v9
    ds_read_b32 v8, v5
    ds_read_b32 v4, v3 offset:16
    v_and_b32_dpp v40, v9, v52 row_newbcast:0 row_mask:0xf bank_mask:0xf
    v_and_b32_dpp v41, v9, v53 row_newbcast:0 row_mask:0xf bank_mask:0xf
    v_and_b32_dpp v42, v9, v54 row_newbcast:0 row_mask:0xf bank_mask:0xf
    v_and_b32_dpp v43, v9, v55 row_newbcast:0 row_mask:0xf bank_mask:0xf
    s_waitcnt vmcnt(7)
    s_cbranch_vccnz Lq_6
    s_waitcnt vmcnt(4)
Lq_6:
    buffer_load_dwordx4 v[96:99], v2, s[48:51], s53 offen offset:0 nt
    v_mfma_f32_16x16x32_bf16 v[60:63], v[40:43], v[64:67], v[60:63]
    v_and_b32_dpp v44, v9, v52 row_newbcast:1 row_mask:0xf bank_mask:0xf
    v_and_b32_dpp v45, v9, v53 row_newbcast:1 row_mask:0xf bank_mask:0xf
    v_and_b32_dpp v46, v9, v54 row_newbcast:1 row_mask:0xf bank_mask:0xf
    v_and_b32_dpp v47, v9, v55 row_newbcast:1 row_mask:0xf bank_mask:0xf
    s_waitcnt vmcnt(7)
    s_cbranch_vccnz Lq_7
    s_waitcnt vmcnt(4)
Lq_7:
    buffer_load_dwordx4 v[100:103], v2, s[48:51], s53 offen offset:512 nt
    v_mfma_f32_16x16x32_bf16 v[60:63], v[44:47], v[68:71], v[60:63]
    v_and_b32_dpp v40, v9, v52 row_newbcast:2 row_mask:0xf bank_mask:0xf
    v_and_b32_dpp v41, v9, v53 row_newbcast:2 row_mask:0xf bank_mask:0xf
    v_and_b32_dpp v42, v9, v54 row_newbcast:2 row_mask:0xf bank_mask:0xf
    v_and_b32_dpp v43, v9, v55 row_newbcast:2 row_mask:0xf bank_mask:0xf
    s_waitcnt vmcnt(7)
    s_cbranch_vccnz Lq_8
    s_waitcnt vmcnt(4)
Lq_8:
    buffer_load_dwordx4 v[104:107], v2, s[48:51], s53 offen offset:1024 nt
    v_mfma_f32_16x16x32_bf16 v[60:63], v[40:43], v[72:75], v[60:63]
    v_and_b32_dpp v44, v9, v52 row_newbcast:3 row_mask:0xf bank_mask:0xf
    v_and_b32_dpp v45, v9, v53 row_newbcast:3 row_mask:0xf bank_mask:0xf
    v_and_b32_dpp v46, v9, v54 row_newbcast:3 row_mask:0xf bank_mask:0xf
    v_and_b32_dpp v47, v9, v55 row_newbcast:3 row_mask:0xf bank_mask:0xf
    s_waitcnt vmcnt(7)
    s_cbranch_vccnz Lq_9
    s_waitcnt vmcnt(4)
Lq_9:
    buffer_load_dwordx4 v[108:111], v2, s[48:51], s53 offen offset:1536 nt
    v_mfma_f32_16x16x32_bf16 v[60:63], v[44:47], v[76:79], v[60:63]
    s_mov_b32 s11, s53
    s_add_u32 s55, s55, 1
    s_waitcnt lgkmcnt(0)
    v_sub_f32 v9, v8, v18
    v_fma_f32 v9, v9, s9, v10
    v_add_u32 v5, v57, v5
    v_exp_f32 v9, v9
    v_mov_b32 v12, s55
    ds_write_b32 v11, v12 offset:32
    v_readfirstlane_b32 s4, v4
    s_nop 0
    s_lshr_b32 s5, s4, 24
    s_add_u32 s5, s5, s55
    s_lshl_b32 s5, s5, 9
    s_or_b32 s5, s5, s4
    s_bitcmp1_b32 s5, 16
    s_cselect_b64 vcc, -1, 0
    s_bfe_u32 s53, s52, 0x30000
    s_lshl_b32 s53, s53, 13
    s_bfe_u32 s4, s52, 0x40003
    s_lshl_b32 s4, s4, 17
    s_or_b32 s53, s53, s4
    s_add_u32 s52, s52, s12
Lgo_12:
    v_cvt_pk_bf16_f32 v9, v9, v9
    ds_read_b32 v8, v5
    ds_read_b32 v4, v3 offset:16
    v_and_b32_dpp v40, v9, v52 row_newbcast:0 row_mask:0xf bank_mask:0xf
    v_and_b32_dpp v41, v9, v53 row_newbcast:0 row_mask:0xf bank_mask:0xf
    v_and_b32_dpp v42, v9, v54 row_newbcast:0 row_mask:0xf bank_mask:0xf
    v_and_b32_dpp v43, v9, v55 row_newbcast:0 row_mask:0xf bank_mask:0xf
    s_waitcnt vmcnt(7)
    s_cbranch_vccnz Lq_13
    s_waitcnt vmcnt(4)
Lq_13:
    buffer_load_dwordx4 v[112:115], v2, s[48:51], s53 offen offset:0 nt
    v_mfma_f32_16x16x32_bf16 v[60:63], v[40:43], v[80:83], v[60:63]
    v_and_b32_dpp v44, v9, v52 row_newbcast:1 row_mask:0xf bank_mask:0xf
    v_and_b32_dpp v45, v9, v53 row_newbcast:1 row_mask:0xf bank_mask:0xf
    v_and_b32_dpp v46, v9, v54 row_newbcast:1 row_mask:0xf bank_mask:0xf
    v_and_b32_dpp v47, v9, v55 row_newbcast:1 row_mask:0xf bank_mask:0xf
    s_waitcnt vmcnt(7)
    s_cbranch_vccnz Lq_14
    s_waitcnt vmcnt(4)
Lq_14:
    buffer_load_dwordx4 v[116:119], v2, s[48:51], s53 offen offset:512 nt
    v_mfma_f32_16x16x32_bf16 v[60:63], v[44:47], v[84:87], v[60:63]
    v_and_b32_dpp v40, v9, v52 row_newbcast:2 row_mask:0xf bank_mask:0xf
    v_and_b32_dpp v41, v9, v53 row_newbcast:2 row_mask:0xf bank_mask:0xf
    v_and_b32_dpp v42, v9, v54 row_newbcast:2 row_mask:0xf bank_mask:0xf
    v_and_b32_dpp v43, v9, v55 row_newbcast:2 row_mask:0xf bank_mask:0xf
    s_waitcnt vmcnt(7)
    s_cbranch_vccnz Lq_15
    s_waitcnt vmcnt(4)
Lq_15:
    buffer_load_dwordx4 v[120:123], v2, s[48:51], s53 offen offset:1024 nt
    v_mfma_f32_16x16x32_bf16 v[60:63], v[40:43], v[88:91], v[60:63]
    v_and_b32_dpp v44, v9, v52 row_newbcast:3 row_mask:0xf bank_mask:0xf
    v_and_b32_dpp v45, v9, v53 row_newbcast:3 row_mask:0xf bank_mask:0xf
    v_and_b32_dpp v46, v9, v54 row_newbcast:3 row_mask:0xf bank_mask:0xf
    v_and_b32_dpp v47, v9, v55 row_newbcast:3 row_mask:0xf bank_mask:0xf
    s_waitcnt vmcnt(7)
    s_cbranch_vccnz Lq_16
    s_waitcnt vmcnt(4)
Lq_16:
    buffer_load_dwordx4 v[124:127], v2, s[48:51], s53 offen offset:1536 nt
    v_mfma_f32_16x16x32_bf16 v[60:63], v[44:47], v[92:95], v[60:63]
    s_mov_b32 s11, s53
    s_add_u32 s55, s55, 1
    s_waitcnt lgkmcnt(0)
    v_sub_f32 v9, v8, v18
    v_fma_f32 v9, v9, s9, v10
    v_add_u32 v5, v57, v5
    v_exp_f32 v9, v9
    v_mov_b32 v12, s55
    ds_write_b32 v11, v12 offset:32
    v_readfirstlane_b32 s4, v4
    s_nop 0
    s_lshr_b32 s5, s4, 24
    s_add_u32 s5, s5, s55
    s_lshl_b32 s5, s5, 9
    s_or_b32 s5, s5, s4
    s_bitcmp1_b32 s5, 16
    s_cselect_b64 vcc, -1, 0
    s_bfe_u32 s53, s52, 0x30000
    s_lshl_b32 s53, s53, 13
    s_bfe_u32 s4, s52, 0x40003
    s_lshl_b32 s4, s4, 17
    s_or_b32 s53, s53, s4
    s_add_u32 s52, s52, s12
Lgo_19:
    v_cvt_pk_bf16_f32 v9, v9, v9
    ds_read_b32 v8, v5
    ds_read_b32 v4, v3 offset:16
    v_and_b32_dpp v40, v9, v52 row_newbcast:0 row_mask:0xf bank_mask:0xf
    v_and_b32_dpp v41, v9, v53 row_newbcast:0 row_mask:0xf bank_mask:0xf
    v_and_b32_dpp v42, v9, v54 row_newbcast:0 row_mask:0xf bank_mask:0xf
    v_and_b32_dpp v43, v9, v55 row_newbcast:0 row_mask:0xf bank_mask:0xf
    s_waitcnt vmcnt(7)
    s_cbranch_vccnz Lq_20
    s_waitcnt vmcnt(4)
Lq_20:
    buffer_load_dwordx4 v[64:67], v2, s[48:51], s53 offen offset:0 nt
    v_mfma_f32_16x16x32_bf16 v[60:63], v[40:43], v[96:99], v[60:63]
    v_and_b32_dpp v44, v9, v52 row_newbcast:1 row_mask:0xf bank_mask:0xf
    v_and_b32_dpp v45, v9, v53 row_newbcast:1 row_mask:0xf bank_mask:0xf
    v_and_b32_dpp v46, v9, v54 row_newbcast:1 row_mask:0xf bank_mask:0xf
    v_and_b32_dpp v47, v9, v55 row_newbcast:1 row_mask:0xf bank_mask:0xf
    s_waitcnt vmcnt(7)
    s_cbranch_vccnz Lq_21
    s_waitcnt vmcnt(4)
Lq_21:
    buffer_load_dwordx4 v[68:71], v2, s[48:51], s53 offen offset:512 nt
    v_mfma_f32_16x16x32_bf16 v[60:63], v[44:47], v[100:103], v[60:63]
    v_and_b32_dpp v40, v9, v52 row_newbcast:2 row_mask:0xf bank_mask:0xf
    v_and_b32_dpp v41, v9, v53 row_newbcast:2 row_mask:0xf bank_mask:0xf
    v_and_b32_dpp v42, v9, v54 row_newbcast:2 row_mask:0xf bank_mask:0xf
    v_and_b32_dpp v43, v9, v55 row_newbcast:2 row_mask:0xf bank_mask:0xf
    s_waitcnt vmcnt(7)
    s_cbranch_vccnz Lq_22
    s_waitcnt vmcnt(4)
Lq_22:
    buffer_load_dwordx4 v[72:75], v2, s[48:51], s53 offen offset:1024 nt
    v_mfma_f32_16x16x32_bf16 v[60:63], v[40:43], v[104:107], v[60:63]
    v_and_b32_dpp v44, v9, v52 row_newbcast:3 row_mask:0xf bank_mask:0xf
    v_and_b32_dpp v45, v9, v53 row_newbcast:3 row_mask:0xf bank_mask:0xf
    v_and_b32_dpp v46, v9, v54 row_newbcast:3 row_mask:0xf bank_mask:0xf
    v_and_b32_dpp v47, v9, v55 row_newbcast:3 row_mask:0xf bank_mask:0xf
    s_waitcnt vmcnt(7)
    s_cbranch_vccnz Lq_23
    s_waitcnt vmcnt(4)
Lq_23:
    buffer_load_dwordx4 v[76:79], v2, s[48:51], s53 offen offset:1536 nt
    v_mfma_f32_16x16x32_bf16 v[60:63], v[44:47], v[108:111], v[60:63]
    s_mov_b32 s11, s53
    s_add_u32 s55, s55, 1
    s_waitcnt lgkmcnt(0)
    v_sub_f32 v9, v8, v18
    v_fma_f32 v9, v9, s9, v10
    v_add_u32 v5, v57, v5
    v_exp_f32 v9, v9
    v_mov_b32 v12, s55
    ds_write_b32 v11, v12 offset:32
    v_readfirstlane_b32 s4, v4
    s_nop 0
    s_lshr_b32 s5, s4, 24
    s_add_u32 s5, s5, s55
    s_lshl_b32 s5, s5, 9
    s_or_b32 s5, s5, s4
    s_bitcmp1_b32 s5, 16
    s_cselect_b64 vcc, -1, 0
    s_bfe_u32 s53, s52, 0x30000
    s_lshl_b32 s53, s53, 13
    s_bfe_u32 s4, s52, 0x40003
    s_lshl_b32 s4, s4, 17
    s_or_b32 s53, s53, s4
    s_add_u32 s52, s52, s12
Lgo_26:
    v_cvt_pk_bf16_f32 v9, v9, v9
    ds_read_b32 v8, v5
    ds_read_b32 v4, v3 offset:16
    v_and_b32_dpp v40, v9, v52 row_newbcast:0 row_mask:0xf bank_mask:0xf
    v_and_b32_dpp v41, v9, v53 row_newbcast:0 row_mask:0xf bank_mask:0xf
    v_and_b32_dpp v42, v9, v54 row_newbcast:0 row_mask:0xf bank_mask:0xf
    v_and_b32_dpp v43, v9, v55 row_newbcast:0 row_mask:0xf bank_mask:0xf
    s_waitcnt vmcnt(7)
    s_cbranch_vccnz Lq_27
    s_waitcnt vmcnt(4)
Lq_27:
    buffer_load_dwordx4 v[80:83], v2, s[48:51], s53 offen offset:0 nt
    v_mfma_f32_16x16x32_bf16 v[60:63], v[40:43], v[112:115], v[60:63]
    v_and_b32_dpp v44, v9, v52 row_newbcast:1 row_mask:0xf bank_mask:0xf
    v_and_b32_dpp v45, v9, v53 row_newbcast:1 row_mask:0xf bank_mask:0xf
    v_and_b32_dpp v46, v9, v54 row_newbcast:1 row_mask:0xf bank_mask:0xf
    v_and_b32_dpp v47, v9, v55 row_newbcast:1 row_mask:0xf bank_mask:0xf
    s_waitcnt vmcnt(7)
    s_cbranch_vccnz Lq_28
    s_waitcnt vmcnt(4)
Lq_28:
    buffer_load_dwordx4 v[84:87], v2, s[48:51], s53 offen offset:512 nt
    v_mfma_f32_16x16x32_bf16 v[60:63], v[44:47], v[116:119], v[60:63]
    v_and_b32_dpp v40, v9, v52 row_newbcast:2 row_mask:0xf bank_mask:0xf
    v_and_b32_dpp v41, v9, v53 row_newbcast:2 row_mask:0xf bank_mask:0xf
    v_and_b32_dpp v42, v9, v54 row_newbcast:2 row_mask:0xf bank_mask:0xf
    v_and_b32_dpp v43, v9, v55 row_newbcast:2 row_mask:0xf bank_mask:0xf
    s_waitcnt vmcnt(7)
    s_cbranch_vccnz Lq_29
    s_waitcnt vmcnt(4)
Lq_29:
    buffer_load_dwordx4 v[88:91], v2, s[48:51], s53 offen offset:1024 nt
    v_mfma_f32_16x16x32_bf16 v[60:63], v[40:43], v[120:123], v[60:63]
    v_and_b32_dpp v44, v9, v52 row_newbcast:3 row_mask:0xf bank_mask:0xf
    v_and_b32_dpp v45, v9, v53 row_newbcast:3 row_mask:0xf bank_mask:0xf
    v_and_b32_dpp v46, v9, v54 row_newbcast:3 row_mask:0xf bank_mask:0xf
    v_and_b32_dpp v47, v9, v55 row_newbcast:3 row_mask:0xf bank_mask:0xf
    s_waitcnt vmcnt(7)
    s_cbranch_vccnz Lq_30
    s_waitcnt vmcnt(4)
Lq_30:
    buffer_load_dwordx4 v[92:95], v2, s[48:51], s53 offen offset:1536 nt
    v_mfma_f32_16x16x32_bf16 v[60:63], v[44:47], v[124:127], v[60:63]
    s_mov_b32 s11, s53
    s_add_u32 s55, s55, 1
    s_cmp_lg_u32 s55, 56
    s_cbranch_scc1 L_v1
    v_mov_b32 v12, 0
Llw_31:
    ds_read_b32 v13, v12 offset:56
    s_waitcnt lgkmcnt(0)
    v_readfirstlane_b32 s4, v13
    s_nop 0
    s_cmp_ge_u32 s4, 12
    s_cbranch_scc1 Llwd_32
    s_sleep 1
    s_branch Llw_31
Llwd_32:
    s_waitcnt lgkmcnt(0)
    v_sub_f32 v9, v8, v18
    v_fma_f32 v9, v9, s9, v10
    v_add_u32 v5, v57, v5
    v_exp_f32 v9, v9
    v_mov_b32 v12, s55
    ds_write_b32 v11, v12 offset:32
    v_readfirstlane_b32 s4, v4
    s_nop 0
    s_lshr_b32 s5, s4, 24
    s_add_u32 s5, s5, s55
    s_lshl_b32 s5, s5, 9
    s_or_b32 s5, s5, s4
    s_bitcmp1_b32 s5, 16
    s_cselect_b64 vcc, -1, 0
    s_bfe_u32 s53, s52, 0x30000
    s_lshl_b32 s53, s53, 13
    s_bfe_u32 s4, s52, 0x40003
    s_lshl_b32 s4, s4, 17
    s_or_b32 s53, s53, s4
    s_add_u32 s52, s52, s12
Lgo_35:
    v_cvt_pk_bf16_f32 v9, v9, v9
    ds_read_b32 v8, v5
    ds_read_b32 v4, v3 offset:16
    v_and_b32_dpp v40, v9, v52 row_newbcast:0 row_mask:0xf bank_mask:0xf
    v_and_b32_dpp v41, v9, v53 row_newbcast:0 row_mask:0xf bank_mask:0xf
    v_and_b32_dpp v42, v9, v54 row_newbcast:0 row_mask:0xf bank_mask:0xf
    v_and_b32_dpp v43, v9, v55 row_newbcast:0 row_mask:0xf bank_mask:0xf
    s_waitcnt vmcnt(7)
    s_cbranch_vccnz Lq_36
    s_waitcnt vmcnt(4)
Lq_36:
    buffer_load_dwordx4 v[96:99], v2, s[48:51], s53 offen offset:0 nt
    v_mfma_f32_16x16x32_bf16 v[60:63], v[40:43], v[64:67], v[60:63]
    ds_read_b64_tr_b16 v[128:129], v232 offset:0
    ds_read_b64_tr_b16 v[130:131], v232 offset:4096
    v_and_b32_dpp v44, v9, v52 row_newbcast:1 row_mask:0xf bank_mask:0xf
    v_and_b32_dpp v45, v9, v53 row_newbcast:1 row_mask:0xf bank_mask:0xf
    v_and_b32_dpp v46, v9, v54 row_newbcast:1 row_mask:0xf bank_mask:0xf
    v_and_b32_dpp v47, v9, v55 row_newbcast:1 row_mask:0xf bank_mask:0xf
    s_waitcnt vmcnt(7)
    s_cbranch_vccnz Lq_37
    s_waitcnt vmcnt(4)
Lq_37:
    buffer_load_dwordx4 v[100:103], v2, s[48:51], s53 offen offset:512 nt
    v_mfma_f32_16x16x32_bf16 v[60:63], v[44:47], v[68:71], v[60:63]
    ds_read_b64_tr_b16 v[132:133], v232 offset:32768
    ds_read_b64_tr_b16 v[134:135], v232 offset:36864
    v_and_b32_dpp v40, v9, v52 row_newbcast:2 row_mask:0xf bank_mask:0xf
    v_and_b32_dpp v41, v9, v53 row_newbcast:2 row_mask:0xf bank_mask:0xf
    v_and_b32_dpp v42, v9, v54 row_newbcast:2 row_mask:0xf bank_mask:0xf
    v_and_b32_dpp v43, v9, v55 row_newbcast:2 row_mask:0xf bank_mask:0xf
    s_waitcnt vmcnt(7)
    s_cbranch_vccnz Lq_38
    s_waitcnt vmcnt(4)
Lq_38:
    buffer_load_dwordx4 v[104:107], v2, s[48:51], s53 offen offset:1024 nt
    v_mfma_f32_16x16x32_bf16 v[60:63], v[40:43], v[72:75], v[60:63]
    ds_read_b64_tr_b16 v[136:137], v232 offset:512
    ds_read_b64_tr_b16 v[138:139], v232 offset:4608
    v_and_b32_dpp v44, v9, v52 row_newbcast:3 row_mask:0xf bank_mask:0xf
    v_and_b32_dpp v45, v9, v53 row_newbcast:3 row_mask:0xf bank_mask:0xf
    v_and_b32_dpp v46, v9, v54 row_newbcast:3 row_mask:0xf bank_mask:0xf
    v_and_b32_dpp v47, v9, v55 row_newbcast:3 row_mask:0xf bank_mask:0xf
    s_waitcnt vmcnt(7)
    s_cbranch_vccnz Lq_39
    s_waitcnt vmcnt(4)
Lq_39:
    buffer_load_dwordx4 v[108:111], v2, s[48:51], s53 offen offset:1536 nt
    v_mfma_f32_16x16x32_bf16 v[60:63], v[44:47], v[76:79], v[60:63]
    ds_read_b64_tr_b16 v[140:141], v232 offset:33280
    ds_read_b64_tr_b16 v[142:143], v232 offset:37376
    s_mov_b32 s11, s53
    s_add_u32 s55, s55, 1
    s_waitcnt lgkmcnt(0)
    v_sub_f32 v9, v8, v18
    v_fma_f32 v9, v9, s9, v10
    v_add_u32 v5, v57, v5
    v_exp_f32 v9, v9
    v_mov_b32 v12, s55
    ds_write_b32 v11, v12 offset:32
    v_readfirstlane_b32 s4, v4
    s_nop 0
    s_lshr_b32 s5, s4, 24
    s_add_u32 s5, s5, s55
    s_lshl_b32 s5, s5, 9
    s_or_b32 s5, s5, s4
    s_bitcmp1_b32 s5, 16
    s_cselect_b64 vcc, -1, 0
    s_bfe_u32 s53, s52, 0x30000
    s_lshl_b32 s53, s53, 13
    s_bfe_u32 s4, s52, 0x40003
    s_lshl_b32 s4, s4, 17
    s_or_b32 s53, s53, s4
    s_add_u32 s52, s52, s12
Lgo_42:
    v_cvt_pk_bf16_f32 v9, v9, v9
    ds_read_b32 v8, v5
    ds_read_b32 v4, v3 offset:16
    v_and_b32_dpp v40, v9, v52 row_newbcast:0 row_mask:0xf bank_mask:0xf
    v_and_b32_dpp v41, v9, v53 row_newbcast:0 row_mask:0xf bank_mask:0xf
    v_and_b32_dpp v42, v9, v54 row_newbcast:0 row_mask:0xf bank_mask:0xf
    v_and_b32_dpp v43, v9, v55 row_newbcast:0 row_mask:0xf bank_mask:0xf
    s_waitcnt vmcnt(7)
    s_cbranch_vccnz Lq_43
    s_waitcnt vmcnt(4)
Lq_43:
    buffer_load_dwordx4 v[112:115], v2, s[48:51], s53 offen offset:0 nt
    v_mfma_f32_16x16x32_bf16 v[60:63], v[40:43], v[80:83], v[60:63]
    ds_read_b64_tr_b16 v[144:145], v233 offset:0
    ds_read_b64_tr_b16 v[146:147], v233 offset:4096
    v_and_b32_dpp v44, v9, v52 row_newbcast:1 row_mask:0xf bank_mask:0xf
    v_and_b32_dpp v45, v9, v53 row_newbcast:1 row_mask:0xf bank_mask:0xf
    v_and_b32_dpp v46, v9, v54 row_newbcast:1 row_mask:0xf bank_mask:0xf
    v_and_b32_dpp v47, v9, v55 row_newbcast:1 row_mask:0xf bank_mask:0xf
    s_waitcnt vmcnt(7)
    s_cbranch_vccnz Lq_44
    s_waitcnt vmcnt(4)
Lq_44:
    buffer_load_dwordx4 v[116:119], v2, s[48:51], s53 offen offset:512 nt
    v_mfma_f32_16x16x32_bf16 v[60:63], v[44:47], v[84:87], v[60:63]
    ds_read_b64_tr_b16 v[148:149], v233 offset:32768
    ds_read_b64_tr_b16 v[150:151], v233 offset:36864
    v_and_b32_dpp v40, v9, v52 row_newbcast:2 row_mask:0xf bank_mask:0xf
    v_and_b32_dpp v41, v9, v53 row_newbcast:2 row_mask:0xf bank_mask:0xf
    v_and_b32_dpp v42, v9, v54 row_newbcast:2 row_mask:0xf bank_mask:0xf
    v_and_b32_dpp v43, v9, v55 row_newbcast:2 row_mask:0xf bank_mask:0xf
    s_waitcnt vmcnt(7)
    s_cbranch_vccnz Lq_45
    s_waitcnt vmcnt(4)
Lq_45:
    buffer_load_dwordx4 v[120:123], v2, s[48:51], s53 offen offset:1024 nt
    v_mfma_f32_16x16x32_bf16 v[60:63], v[40:43], v[88:91], v[60:63]
    ds_read_b64_tr_b16 v[152:153], v233 offset:512
    ds_read_b64_tr_b16 v[154:155], v233 offset:4608
    v_and_b32_dpp v44, v9, v52 row_newbcast:3 row_mask:0xf bank_mask:0xf
    v_and_b32_dpp v45, v9, v53 row_newbcast:3 row_mask:0xf bank_mask:0xf
    v_and_b32_dpp v46, v9, v54 row_newbcast:3 row_mask:0xf bank_mask:0xf
    v_and_b32_dpp v47, v9, v55 row_newbcast:3 row_mask:0xf bank_mask:0xf
    s_waitcnt vmcnt(7)
    s_cbranch_vccnz Lq_46
    s_waitcnt vmcnt(4)
Lq_46:
    buffer_load_dwordx4 v[124:127], v2, s[48:51], s53 offen offset:1536 nt
    v_mfma_f32_16x16x32_bf16 v[60:63], v[44:47], v[92:95], v[60:63]
    ds_read_b64_tr_b16 v[156:157], v233 offset:33280
    ds_read_b64_tr_b16 v[158:159], v233 offset:37376
    s_mov_b32 s11, s53
    s_add_u32 s55, s55, 1
    s_waitcnt lgkmcnt(0)
    v_sub_f32 v9, v8, v18
    v_fma_f32 v9, v9, s9, v10
    v_add_u32 v5, v57, v5
    v_exp_f32 v9, v9
    v_mov_b32 v12, s55
    ds_write_b32 v11, v12 offset:32
    v_readfirstlane_b32 s4, v4
    s_nop 0
    s_lshr_b32 s5, s4, 24
    s_add_u32 s5, s5, s55
    s_lshl_b32 s5, s5, 9
    s_or_b32 s5, s5, s4
    s_bitcmp1_b32 s5, 16
    s_cselect_b64 vcc, -1, 0
Lchk_47:
    v_readfirstlane_b32 s4, v4
    s_nop 0
    s_and_b32 s5, s4, 0xffff
    s_add_u32 s5, s5, 58
    s_cmp_lt_u32 s55, s5
    s_cbranch_scc1 Lok_48
    s_mov_b32 s53, 0x40000000
    s_add_u32 s13, s5, 2
    s_bitcmp1_b32 s4, 16
    s_cbranch_scc1 Lgo_49
    s_mov_b32 s13, 0xffff
    ds_read_b32 v4, v3 offset:16
    s_waitcnt lgkmcnt(0)
    s_branch Lchk_47
Lok_48:
    s_bfe_u32 s53, s52, 0x30000
    s_lshl_b32 s53, s53, 13
    s_bfe_u32 s4, s52, 0x40003
    s_lshl_b32 s4, s4, 17
    s_or_b32 s53, s53, s4
    s_add_u32 s52, s52, s12
Lgo_49:
    v_cvt_pk_bf16_f32 v9, v9, v9
    ds_read_b32 v8, v5
    ds_read_b32 v4, v3 offset:16
    v_and_b32_dpp v40, v9, v52 row_newbcast:0 row_mask:0xf bank_mask:0xf
    v_and_b32_dpp v41, v9, v53 row_newbcast:0 row_mask:0xf bank_mask:0xf
    v_and_b32_dpp v42, v9, v54 row_newbcast:0 row_mask:0xf bank_mask:0xf
    v_and_b32_dpp v43, v9, v55 row_newbcast:0 row_mask:0xf bank_mask:0xf
    s_waitcnt vmcnt(7)
    s_cbranch_vccnz Lq_50
    s_waitcnt vmcnt(4)
Lq_50:
    buffer_load_dwordx4 v[64:67], v2, s[48:51], s53 offen offset:0 nt
    v_mfma_f32_16x16x32_bf16 v[60:63], v[40:43], v[96:99], v[60:63]
    ds_read_b64_tr_b16 v[160:161], v234 offset:0
    ds_read_b64_tr_b16 v[162:163], v234 offset:4096
    v_and_b32_dpp v44, v9, v52 row_newbcast:1 row_mask:0xf bank_mask:0xf
    v_and_b32_dpp v45, v9, v53 row_newbcast:1 row_mask:0xf bank_mask:0xf
    v_and_b32_dpp v46, v9, v54 row_newbcast:1 row_mask:0xf bank_mask:0xf
    v_and_b32_dpp v47, v9, v55 row_newbcast:1 row_mask:0xf bank_mask:0xf
    s_waitcnt vmcnt(7)
    s_cbranch_vccnz Lq_51
    s_waitcnt vmcnt(4)
Lq_51:
    buffer_load_dwordx4 v[68:71], v2, s[48:51], s53 offen offset:512 nt
    v_mfma_f32_16x16x32_bf16 v[60:63], v[44:47], v[100:103], v[60:63]
    ds_read_b64_tr_b16 v[164:165], v234 offset:32768
    ds_read_b64_tr_b16 v[166:167], v234 offset:36864
    v_and_b32_dpp v40, v9, v52 row_newbcast:2 row_mask:0xf bank_mask:0xf
    v_and_b32_dpp v41, v9, v53 row_newbcast:2 row_mask:0xf bank_mask:0xf
    v_and_b32_dpp v42, v9, v54 row_newbcast:2 row_mask:0xf bank_mask:0xf
    v_and_b32_dpp v43, v9, v55 row_newbcast:2 row_mask:0xf bank_mask:0xf
    s_waitcnt vmcnt(7)
    s_cbranch_vccnz Lq_52
    s_waitcnt vmcnt(4)
Lq_52:
    buffer_load_dwordx4 v[72:75], v2, s[48:51], s53 offen offset:1024 nt
    v_mfma_f32_16x16x32_bf16 v[60:63], v[40:43], v[104:107], v[60:63]
    ds_read_b64_tr_b16 v[168:169], v234 offset:512
    ds_read_b64_tr_b16 v[170:171], v234 offset:4608
    v_and_b32_dpp v44, v9, v52 row_newbcast:3 row_mask:0xf bank_mask:0xf
    v_and_b32_dpp v45, v9, v53 row_newbcast:3 row_mask:0xf bank_mask:0xf
    v_and_b32_dpp v46, v9, v54 row_newbcast:3 row_mask:0xf bank_mask:0xf
    v_and_b32_dpp v47, v9, v55 row_newbcast:3 row_mask:0xf bank_mask:0xf
    s_waitcnt vmcnt(7)
    s_cbranch_vccnz Lq_53
    s_waitcnt vmcnt(4)
Lq_53:
    buffer_load_dwordx4 v[76:79], v2, s[48:51], s53 offen offset:1536 nt
    v_mfma_f32_16x16x32_bf16 v[60:63], v[44:47], v[108:111], v[60:63]
    ds_read_b64_tr_b16 v[172:173], v234 offset:33280
    ds_read_b64_tr_b16 v[174:175], v234 offset:37376
    s_mov_b32 s11, s53
    s_add_u32 s55, s55, 1
    s_waitcnt lgkmcnt(0)
    v_sub_f32 v9, v8, v18
    v_fma_f32 v9, v9, s9, v10
    v_add_u32 v5, v57, v5
    v_exp_f32 v9, v9
    v_mov_b32 v12, s55
    ds_write_b32 v11, v12 offset:32
    v_readfirstlane_b32 s4, v4
    s_nop 0
    s_lshr_b32 s5, s4, 24
    s_add_u32 s5, s5, s55
    s_lshl_b32 s5, s5, 9
    s_or_b32 s5, s5, s4
    s_bitcmp1_b32 s5, 16
    s_cselect_b64 vcc, -1, 0
Lchk_54:
    v_readfirstlane_b32 s4, v4
    s_nop 0
    s_and_b32 s5, s4, 0xffff
    s_add_u32 s5, s5, 58
    s_cmp_lt_u32 s55, s5
    s_cbranch_scc1 Lok_55
    s_mov_b32 s53, 0x40000000
    s_add_u32 s13, s5, 2
    s_bitcmp1_b32 s4, 16
    s_cbranch_scc1 Lgo_56
    s_mov_b32 s13, 0xffff
    ds_read_b32 v4, v3 offset:16
    s_waitcnt lgkmcnt(0)
    s_branch Lchk_54
Lok_55:
    s_bfe_u32 s53, s52, 0x30000
    s_lshl_b32 s53, s53, 13
    s_bfe_u32 s4, s52, 0x40003
    s_lshl_b32 s4, s4, 17
    s_or_b32 s53, s53, s4
    s_add_u32 s52, s52, s12
Lgo_56:
    v_cvt_pk_bf16_f32 v9, v9, v9
    ds_read_b32 v8, v5
    ds_read_b32 v4, v3 offset:16
    v_and_b32_dpp v40, v9, v52 row_newbcast:0 row_mask:0xf bank_mask:0xf
    v_and_b32_dpp v41, v9, v53 row_newbcast:0 row_mask:0xf bank_mask:0xf
    v_and_b32_dpp v42, v9, v54 row_newbcast:0 row_mask:0xf bank_mask:0xf
    v_and_b32_dpp v43, v9, v55 row_newbcast:0 row_mask:0xf bank_mask:0xf
    s_waitcnt vmcnt(7)
    s_cbranch_vccnz Lq_57
    s_waitcnt vmcnt(4)
Lq_57:
    buffer_load_dwordx4 v[80:83], v2, s[48:51], s53 offen offset:0 nt
    v_mfma_f32_16x16x32_bf16 v[60:63], v[40:43], v[112:115], v[60:63]
    ds_read_b64_tr_b16 v[176:177], v235 offset:0
    ds_read_b64_tr_b16 v[178:179], v235 offset:4096
    v_and_b32_dpp v44, v9, v52 row_newbcast:1 row_mask:0xf bank_mask:0xf
    v_and_b32_dpp v45, v9, v53 row_newbcast:1 row_mask:0xf bank_mask:0xf
    v_and_b32_dpp v46, v9, v54 row_newbcast:1 row_mask:0xf bank_mask:0xf
    v_and_b32_dpp v47, v9, v55 row_newbcast:1 row_mask:0xf bank_mask:0xf
    s_waitcnt vmcnt(7)
    s_cbranch_vccnz Lq_58
    s_waitcnt vmcnt(4)
Lq_58:
    buffer_load_dwordx4 v[84:87], v2, s[48:51], s53 offen offset:512 nt
    v_mfma_f32_16x16x32_bf16 v[60:63], v[44:47], v[116:119], v[60:63]
    ds_read_b64_tr_b16 v[180:181], v235 offset:32768
    ds_read_b64_tr_b16 v[182:183], v235 offset:36864
    v_and_b32_dpp v40, v9, v52 row_newbcast:2 row_mask:0xf bank_mask:0xf
    v_and_b32_dpp v41, v9, v53 row_newbcast:2 row_mask:0xf bank_mask:0xf
    v_and_b32_dpp v42, v9, v54 row_newbcast:2 row_mask:0xf bank_mask:0xf
    v_and_b32_dpp v43, v9, v55 row_newbcast:2 row_mask:0xf bank_mask:0xf
    s_waitcnt vmcnt(7)
    s_cbranch_vccnz Lq_59
    s_waitcnt vmcnt(4)
Lq_59:
    buffer_load_dwordx4 v[88:91], v2, s[48:51], s53 offen offset:1024 nt
    v_mfma_f32_16x16x32_bf16 v[60:63], v[40:43], v[120:123], v[60:63]
    ds_read_b64_tr_b16 v[184:185], v235 offset:512
    ds_read_b64_tr_b16 v[186:187], v235 offset:4608
    v_and_b32_dpp v44, v9, v52 row_newbcast:3 row_mask:0xf bank_mask:0xf
    v_and_b32_dpp v45, v9, v53 row_newbcast:3 row_mask:0xf bank_mask:0xf
    v_and_b32_dpp v46, v9, v54 row_newbcast:3 row_mask:0xf bank_mask:0xf
    v_and_b32_dpp v47, v9, v55 row_newbcast:3 row_mask:0xf bank_mask:0xf
    s_waitcnt vmcnt(7)
    s_cbranch_vccnz Lq_60
    s_waitcnt vmcnt(4)
Lq_60:
    buffer_load_dwordx4 v[92:95], v2, s[48:51], s53 offen offset:1536 nt
    v_mfma_f32_16x16x32_bf16 v[60:63], v[44:47], v[124:127], v[60:63]
    ds_read_b64_tr_b16 v[188:189], v235 offset:33280
    ds_read_b64_tr_b16 v[190:191], v235 offset:37376
    s_mov_b32 s11, s53
    s_add_u32 s55, s55, 1
    ds_read_b64 v[12:13], v3 offset:24
    s_waitcnt lgkmcnt(0)
    v_sub_f32 v14, v18, v12
    v_mov_b32 v18, v12
    v_mov_b32 v10, v13
    v_fma_f32 v14, v14, s9, v13
    v_exp_f32 v14, v14
    s_nop 0
    v_mul_f32 v60, v60, v14
    v_mul_f32 v61, v61, v14
    v_mul_f32 v62, v62, v14
    v_mul_f32 v63, v63, v14
    s_cmp_eq_u32 s55, s13
    s_cbranch_scc1 L_vdone
L_v2:
    s_waitcnt lgkmcnt(0)
    v_sub_f32 v9, v8, v18
    v_fma_f32 v9, v9, s9, v10
    v_add_u32 v5, v57, v5
    v_exp_f32 v9, v9
    v_mov_b32 v12, s55
    ds_write_b32 v11, v12 offset:32
    v_readfirstlane_b32 s4, v4
    s_nop 0
    s_lshr_b32 s5, s4, 24
    s_add_u32 s5, s5, s55
    s_lshl_b32 s5, s5, 9
    s_or_b32 s5, s5, s4
    s_bitcmp1_b32 s5, 16
    s_cselect_b64 vcc, -1, 0
Lchk_61:
    v_readfirstlane_b32 s4, v4
    s_nop 0
    s_and_b32 s5, s4, 0xffff
    s_add_u32 s5, s5, 58
    s_cmp_lt_u32 s55, s5
    s_cbranch_scc1 Lok_62
    s_mov_b32 s53, 0x40000000
    s_add_u32 s13, s5, 2
    s_bitcmp1_b32 s4, 16
    s_cbranch_scc1 Lgo_63
    s_mov_b32 s13, 0xffff
    ds_read_b32 v4, v3 offset:16
    s_waitcnt lgkmcnt(0)
    s_branch Lchk_61
Lok_62:
    s_bfe_u32 s53, s52, 0x30000
    s_lshl_b32 s53, s53, 13
    s_bfe_u32 s4, s52, 0x40003
    s_lshl_b32 s4, s4, 17
    s_or_b32 s53, s53, s4
    s_add_u32 s52, s52, s12
Lgo_63:
    v_cvt_pk_bf16_f32 v9, v9, v9
    ds_read_b32 v8, v5
    ds_read_b32 v4, v3 offset:16
    v_and_b32_dpp v40, v9, v52 row_newbcast:0 row_mask:0xf bank_mask:0xf
    v_and_b32_dpp v41, v9, v53 row_newbcast:0 row_mask:0xf bank_mask:0xf
    v_and_b32_dpp v42, v9, v54 row_newbcast:0 row_mask:0xf bank_mask:0xf
    v_and_b32_dpp v43, v9, v55 row_newbcast:0 row_mask:0xf bank_mask:0xf
    s_waitcnt vmcnt(7)
    s_cbranch_vccnz Lq_64
    s_waitcnt vmcnt(4)
Lq_64:
    buffer_load_dwordx4 v[96:99], v2, s[48:51], s53 offen offset:0 nt
    v_mfma_f32_16x16x32_bf16 v[60:63], v[40:43], v[64:67], v[60:63]
    v_and_b32_dpp v44, v9, v52 row_newbcast:1 row_mask:0xf bank_mask:0xf
    v_and_b32_dpp v45, v9, v53 row_newbcast:1 row_mask:0xf bank_mask:0xf
    v_and_b32_dpp v46, v9, v54 row_newbcast:1 row_mask:0xf bank_mask:0xf
    v_and_b32_dpp v47, v9, v55 row_newbcast:1 row_mask:0xf bank_mask:0xf
    s_waitcnt vmcnt(7)
    s_cbranch_vccnz Lq_65
    s_waitcnt vmcnt(4)
Lq_65:
    buffer_load_dwordx4 v[100:103], v2, s[48:51], s53 offen offset:512 nt
    v_mfma_f32_16x16x32_bf16 v[60:63], v[44:47], v[68:71], v[60:63]
    v_and_b32_dpp v40, v9, v52 row_newbcast:2 row_mask:0xf bank_mask:0xf
    v_and_b32_dpp v41, v9, v53 row_newbcast:2 row_mask:0xf bank_mask:0xf
    v_and_b32_dpp v42, v9, v54 row_newbcast:2 row_mask:0xf bank_mask:0xf
    v_and_b32_dpp v43, v9, v55 row_newbcast:2 row_mask:0xf bank_mask:0xf
    s_waitcnt vmcnt(7)
    s_cbranch_vccnz Lq_66
    s_waitcnt vmcnt(4)
Lq_66:
    buffer_load_dwordx4 v[104:107], v2, s[48:51], s53 offen offset:1024 nt
    v_mfma_f32_16x16x32_bf16 v[60:63], v[40:43], v[72:75], v[60:63]
    v_and_b32_dpp v44, v9, v52 row_newbcast:3 row_mask:0xf bank_mask:0xf
    v_and_b32_dpp v45, v9, v53 row_newbcast:3 row_mask:0xf bank_mask:0xf
    v_and_b32_dpp v46, v9, v54 row_newbcast:3 row_mask:0xf bank_mask:0xf
    v_and_b32_dpp v47, v9, v55 row_newbcast:3 row_mask:0xf bank_mask:0xf
    s_waitcnt vmcnt(7)
    s_cbranch_vccnz Lq_67
    s_waitcnt vmcnt(4)
Lq_67:
    buffer_load_dwordx4 v[108:111], v2, s[48:51], s53 offen offset:1536 nt
    v_mfma_f32_16x16x32_bf16 v[60:63], v[44:47], v[76:79], v[60:63]
    s_mov_b32 s11, s53
    s_add_u32 s55, s55, 1
    s_cmp_eq_u32 s55, s13
    s_cbranch_scc1 L_vdone
    s_waitcnt lgkmcnt(0)
    v_sub_f32 v9, v8, v18
    v_fma_f32 v9, v9, s9, v10
    v_add_u32 v5, v57, v5
    v_exp_f32 v9, v9
    v_mov_b32 v12, s55
    ds_write_b32 v11, v12 offset:32
    v_readfirstlane_b32 s4, v4
    s_nop 0
    s_lshr_b32 s5, s4, 24
    s_add_u32 s5, s5, s55
    s_lshl_b32 s5, s5, 9
    s_or_b32 s5, s5, s4
    s_bitcmp1_b32 s5, 16
    s_cselect_b64 vcc, -1, 0
Lchk_68:
    v_readfirstlane_b32 s4, v4
    s_nop 0
    s_and_b32 s5, s4, 0xffff
    s_add_u32 s5, s5, 58
    s_cmp_lt_u32 s55, s5
    s_cbranch_scc1 Lok_69
    s_mov_b32 s53, 0x40000000
    s_add_u32 s13, s5, 2
    s_bitcmp1_b32 s4, 16
    s_cbranch_scc1 Lgo_70
    s_mov_b32 s13, 0xffff
    ds_read_b32 v4, v3 offset:16
    s_waitcnt lgkmcnt(0)
    s_branch Lchk_68
Lok_69:
    s_bfe_u32 s53, s52, 0x30000
    s_lshl_b32 s53, s53, 13
    s_bfe_u32 s4, s52, 0x40003
    s_lshl_b32 s4, s4, 17
    s_or_b32 s53, s53, s4
    s_add_u32 s52, s52, s12
Lgo_70:
    v_cvt_pk_bf16_f32 v9, v9, v9
    ds_read_b32 v8, v5
    ds_read_b32 v4, v3 offset:16
    v_and_b32_dpp v40, v9, v52 row_newbcast:0 row_mask:0xf bank_mask:0xf
    v_and_b32_dpp v41, v9, v53 row_newbcast:0 row_mask:0xf bank_mask:0xf
    v_and_b32_dpp v42, v9, v54 row_newbcast:0 row_mask:0xf bank_mask:0xf
    v_and_b32_dpp v43, v9, v55 row_newbcast:0 row_mask:0xf bank_mask:0xf
    s_waitcnt vmcnt(7)
    s_cbranch_vccnz Lq_71
    s_waitcnt vmcnt(4)
Lq_71:
    buffer_load_dwordx4 v[112:115], v2, s[48:51], s53 offen offset:0 nt
    v_mfma_f32_16x16x32_bf16 v[60:63], v[40:43], v[80:83], v[60:63]
    v_and_b32_dpp v44, v9, v52 row_newbcast:1 row_mask:0xf bank_mask:0xf
    v_and_b32_dpp v45, v9, v53 row_newbcast:1 row_mask:0xf bank_mask:0xf
    v_and_b32_dpp v46, v9, v54 row_newbcast:1 row_mask:0xf bank_mask:0xf
    v_and_b32_dpp v47, v9, v55 row_newbcast:1 row_mask:0xf bank_mask:0xf
    s_waitcnt vmcnt(7)
    s_cbranch_vccnz Lq_72
    s_waitcnt vmcnt(4)
Lq_72:
    buffer_load_dwordx4 v[116:119], v2, s[48:51], s53 offen offset:512 nt
    v_mfma_f32_16x16x32_bf16 v[60:63], v[44:47], v[84:87], v[60:63]
    v_and_b32_dpp v40, v9, v52 row_newbcast:2 row_mask:0xf bank_mask:0xf
    v_and_b32_dpp v41, v9, v53 row_newbcast:2 row_mask:0xf bank_mask:0xf
    v_and_b32_dpp v42, v9, v54 row_newbcast:2 row_mask:0xf bank_mask:0xf
    v_and_b32_dpp v43, v9, v55 row_newbcast:2 row_mask:0xf bank_mask:0xf
    s_waitcnt vmcnt(7)
    s_cbranch_vccnz Lq_73
    s_waitcnt vmcnt(4)
Lq_73:
    buffer_load_dwordx4 v[120:123], v2, s[48:51], s53 offen offset:1024 nt
    v_mfma_f32_16x16x32_bf16 v[60:63], v[40:43], v[88:91], v[60:63]
    v_and_b32_dpp v44, v9, v52 row_newbcast:3 row_mask:0xf bank_mask:0xf
    v_and_b32_dpp v45, v9, v53 row_newbcast:3 row_mask:0xf bank_mask:0xf
    v_and_b32_dpp v46, v9, v54 row_newbcast:3 row_mask:0xf bank_mask:0xf
    v_and_b32_dpp v47, v9, v55 row_newbcast:3 row_mask:0xf bank_mask:0xf
    s_waitcnt vmcnt(7)
    s_cbranch_vccnz Lq_74
    s_waitcnt vmcnt(4)
Lq_74:
    buffer_load_dwordx4 v[124:127], v2, s[48:51], s53 offen offset:1536 nt
    v_mfma_f32_16x16x32_bf16 v[60:63], v[44:47], v[92:95], v[60:63]
    s_mov_b32 s11, s53
    s_add_u32 s55, s55, 1
    s_cmp_eq_u32 s55, s13
    s_cbranch_scc1 L_vdone
    s_waitcnt lgkmcnt(0)
    v_sub_f32 v9, v8, v18
    v_fma_f32 v9, v9, s9, v10
    v_add_u32 v5, v57, v5
    v_exp_f32 v9, v9
    v_mov_b32 v12, s55
    ds_write_b32 v11, v12 offset:32
    v_readfirstlane_b32 s4, v4
    s_nop 0
    s_lshr_b32 s5, s4, 24
    s_add_u32 s5, s5, s55
    s_lshl_b32 s5, s5, 9
    s_or_b32 s5, s5, s4
    s_bitcmp1_b32 s5, 16
    s_cselect_b64 vcc, -1, 0
Lchk_75:
    v_readfirstlane_b32 s4, v4
    s_nop 0
    s_and_b32 s5, s4, 0xffff
    s_add_u32 s5, s5, 58
    s_cmp_lt_u32 s55, s5
    s_cbranch_scc1 Lok_76
    s_mov_b32 s53, 0x40000000
    s_add_u32 s13, s5, 2
    s_bitcmp1_b32 s4, 16
    s_cbranch_scc1 Lgo_77
    s_mov_b32 s13, 0xffff
    ds_read_b32 v4, v3 offset:16
    s_waitcnt lgkmcnt(0)
    s_branch Lchk_75
Lok_76:
    s_bfe_u32 s53, s52, 0x30000
    s_lshl_b32 s53, s53, 13
    s_bfe_u32 s4, s52, 0x40003
    s_lshl_b32 s4, s4, 17
    s_or_b32 s53, s53, s4
    s_add_u32 s52, s52, s12
Lgo_77:
    v_cvt_pk_bf16_f32 v9, v9, v9
    ds_read_b32 v8, v5
    ds_read_b32 v4, v3 offset:16
    v_and_b32_dpp v40, v9, v52 row_newbcast:0 row_mask:0xf bank_mask:0xf
    v_and_b32_dpp v41, v9, v53 row_newbcast:0 row_mask:0xf bank_mask:0xf
    v_and_b32_dpp v42, v9, v54 row_newbcast:0 row_mask:0xf bank_mask:0xf
    v_and_b32_dpp v43, v9, v55 row_newbcast:0 row_mask:0xf bank_mask:0xf
    s_waitcnt vmcnt(7)
    s_cbranch_vccnz Lq_78
    s_waitcnt vmcnt(4)
Lq_78:
    buffer_load_dwordx4 v[64:67], v2, s[48:51], s53 offen offset:0 nt
    v_mfma_f32_16x16x32_bf16 v[60:63], v[40:43], v[96:99], v[60:63]
    v_and_b32_dpp v44, v9, v52 row_newbcast:1 row_mask:0xf bank_mask:0xf
    v_and_b32_dpp v45, v9, v53 row_newbcast:1 row_mask:0xf bank_mask:0xf
    v_and_b32_dpp v46, v9, v54 row_newbcast:1 row_mask:0xf bank_mask:0xf
    v_and_b32_dpp v47, v9, v55 row_newbcast:1 row_mask:0xf bank_mask:0xf
    s_waitcnt vmcnt(7)
    s_cbranch_vccnz Lq_79
    s_waitcnt vmcnt(4)
Lq_79:
    buffer_load_dwordx4 v[68:71], v2, s[48:51], s53 offen offset:512 nt
    v_mfma_f32_16x16x32_bf16 v[60:63], v[44:47], v[100:103], v[60:63]
    v_and_b32_dpp v40, v9, v52 row_newbcast:2 row_mask:0xf bank_mask:0xf
    v_and_b32_dpp v41, v9, v53 row_newbcast:2 row_mask:0xf bank_mask:0xf
    v_and_b32_dpp v42, v9, v54 row_newbcast:2 row_mask:0xf bank_mask:0xf
    v_and_b32_dpp v43, v9, v55 row_newbcast:2 row_mask:0xf bank_mask:0xf
    s_waitcnt vmcnt(7)
    s_cbranch_vccnz Lq_80
    s_waitcnt vmcnt(4)
Lq_80:
    buffer_load_dwordx4 v[72:75], v2, s[48:51], s53 offen offset:1024 nt
    v_mfma_f32_16x16x32_bf16 v[60:63], v[40:43], v[104:107], v[60:63]
    v_and_b32_dpp v44, v9, v52 row_newbcast:3 row_mask:0xf bank_mask:0xf
    v_and_b32_dpp v45, v9, v53 row_newbcast:3 row_mask:0xf bank_mask:0xf
    v_and_b32_dpp v46, v9, v54 row_newbcast:3 row_mask:0xf bank_mask:0xf
    v_and_b32_dpp v47, v9, v55 row_newbcast:3 row_mask:0xf bank_mask:0xf
    s_waitcnt vmcnt(7)
    s_cbranch_vccnz Lq_81
    s_waitcnt vmcnt(4)
Lq_81:
    buffer_load_dwordx4 v[76:79], v2, s[48:51], s53 offen offset:1536 nt
    v_mfma_f32_16x16x32_bf16 v[60:63], v[44:47], v[108:111], v[60:63]
    s_mov_b32 s11, s53
    s_add_u32 s55, s55, 1
    s_cmp_eq_u32 s55, s13
    s_cbranch_scc1 L_vdone
    s_waitcnt lgkmcnt(0)
    v_sub_f32 v9, v8, v18
    v_fma_f32 v9, v9, s9, v10
    v_add_u32 v5, v57, v5
    v_exp_f32 v9, v9
    v_mov_b32 v12, s55
    ds_write_b32 v11, v12 offset:32
    v_readfirstlane_b32 s4, v4
    s_nop 0
    s_lshr_b32 s5, s4, 24
    s_add_u32 s5, s5, s55
    s_lshl_b32 s5, s5, 9
    s_or_b32 s5, s5, s4
    s_bitcmp1_b32 s5, 16
    s_cselect_b64 vcc, -1, 0
Lchk_82:
    v_readfirstlane_b32 s4, v4
    s_nop 0
    s_and_b32 s5, s4, 0xffff
    s_add_u32 s5, s5, 58
    s_cmp_lt_u32 s55, s5
    s_cbranch_scc1 Lok_83
    s_mov_b32 s53, 0x40000000
    s_add_u32 s13, s5, 2
    s_bitcmp1_b32 s4, 16
    s_cbranch_scc1 Lgo_84
    s_mov_b32 s13, 0xffff
    ds_read_b32 v4, v3 offset:16
    s_waitcnt lgkmcnt(0)
    s_branch Lchk_82
Lok_83:
    s_bfe_u32 s53, s52, 0x30000
    s_lshl_b32 s53, s53, 13
    s_bfe_u32 s4, s52, 0x40003
    s_lshl_b32 s4, s4, 17
    s_or_b32 s53, s53, s4
    s_add_u32 s52, s52, s12
Lgo_84:
    v_cvt_pk_bf16_f32 v9, v9, v9
    ds_read_b32 v8, v5
    ds_read_b32 v4, v3 offset:16
    v_and_b32_dpp v40, v9, v52 row_newbcast:0 row_mask:0xf bank_mask:0xf
    v_and_b32_dpp v41, v9, v53 row_newbcast:0 row_mask:0xf bank_mask:0xf
    v_and_b32_dpp v42, v9, v54 row_newbcast:0 row_mask:0xf bank_mask:0xf
    v_and_b32_dpp v43, v9, v55 row_newbcast:0 row_mask:0xf bank_mask:0xf
    s_waitcnt vmcnt(7)
    s_cbranch_vccnz Lq_85
    s_waitcnt vmcnt(4)
Lq_85:
    buffer_load_dwordx4 v[80:83], v2, s[48:51], s53 offen offset:0 nt
    v_mfma_f32_16x16x32_bf16 v[60:63], v[40:43], v[112:115], v[60:63]
    v_and_b32_dpp v44, v9, v52 row_newbcast:1 row_mask:0xf bank_mask:0xf
    v_and_b32_dpp v45, v9, v53 row_newbcast:1 row_mask:0xf bank_mask:0xf
    v_and_b32_dpp v46, v9, v54 row_newbcast:1 row_mask:0xf bank_mask:0xf
    v_and_b32_dpp v47, v9, v55 row_newbcast:1 row_mask:0xf bank_mask:0xf
    s_waitcnt vmcnt(7)
    s_cbranch_vccnz Lq_86
    s_waitcnt vmcnt(4)
Lq_86:
    buffer_load_dwordx4 v[84:87], v2, s[48:51], s53 offen offset:512 nt
    v_mfma_f32_16x16x32_bf16 v[60:63], v[44:47], v[116:119], v[60:63]
    v_and_b32_dpp v40, v9, v52 row_newbcast:2 row_mask:0xf bank_mask:0xf
    v_and_b32_dpp v41, v9, v53 row_newbcast:2 row_mask:0xf bank_mask:0xf
    v_and_b32_dpp v42, v9, v54 row_newbcast:2 row_mask:0xf bank_mask:0xf
    v_and_b32_dpp v43, v9, v55 row_newbcast:2 row_mask:0xf bank_mask:0xf
    s_waitcnt vmcnt(7)
    s_cbranch_vccnz Lq_87
    s_waitcnt vmcnt(4)
Lq_87:
    buffer_load_dwordx4 v[88:91], v2, s[48:51], s53 offen offset:1024 nt
    v_mfma_f32_16x16x32_bf16 v[60:63], v[40:43], v[120:123], v[60:63]
    v_and_b32_dpp v44, v9, v52 row_newbcast:3 row_mask:0xf bank_mask:0xf
    v_and_b32_dpp v45, v9, v53 row_newbcast:3 row_mask:0xf bank_mask:0xf
    v_and_b32_dpp v46, v9, v54 row_newbcast:3 row_mask:0xf bank_mask:0xf
    v_and_b32_dpp v47, v9, v55 row_newbcast:3 row_mask:0xf bank_mask:0xf
    s_waitcnt vmcnt(7)
    s_cbranch_vccnz Lq_88
    s_waitcnt vmcnt(4)
Lq_88:
    buffer_load_dwordx4 v[92:95], v2, s[48:51], s53 offen offset:1536 nt
    v_mfma_f32_16x16x32_bf16 v[60:63], v[44:47], v[124:127], v[60:63]
    s_mov_b32 s11, s53
    s_add_u32 s55, s55, 1
    s_cmp_lg_u32 s55, s13
    s_cbranch_scc1 L_v2
L_vdone:
    s_mov_b32 exec_lo, 0xffffffff
    s_mov_b32 exec_hi, 0x0
    s_nop 1
    v_cvt_pk_bf16_f32 v12, v60, v61
    v_cvt_pk_bf16_f32 v13, v62, v63
    ds_write_b64 v16, v[12:13] offset:10240
    s_mov_b64 exec, -1
    s_waitcnt lgkmcnt(0)
    s_barrier
    ds_read_b128 v[192:195], v226 offset:10240
    ds_read_b128 v[196:199], v226 offset:10304
    ds_read_b128 v[200:203], v226 offset:10368
    ds_read_b128 v[204:207], v226 offset:10432
    s_waitcnt lgkmcnt(3)
    v_mfma_f32_16x16x32_bf16 v[208:211], v[192:195], v[128:131], 0
    v_mfma_f32_16x16x32_bf16 v[212:215], v[192:195], v[144:147], 0
    v_mfma_f32_16x16x32_bf16 v[216:219], v[192:195], v[160:163], 0
    v_mfma_f32_16x16x32_bf16 v[220:223], v[192:195], v[176:179], 0
    s_waitcnt lgkmcnt(2)
    v_mfma_f32_16x16x32_bf16 v[208:211], v[196:199], v[132:135], v[208:211]
    v_mfma_f32_16x16x32_bf16 v[212:215], v[196:199], v[148:151], v[212:215]
    v_mfma_f32_16x16x32_bf16 v[216:219], v[196:199], v[164:167], v[216:219]
    v_mfma_f32_16x16x32_bf16 v[220:223], v[196:199], v[180:183], v[220:223]
    s_waitcnt lgkmcnt(1)
    v_mfma_f32_16x16x32_bf16 v[208:211], v[200:203], v[136:139], v[208:211]
    v_mfma_f32_16x16x32_bf16 v[212:215], v[200:203], v[152:155], v[212:215]
    v_mfma_f32_16x16x32_bf16 v[216:219], v[200:203], v[168:171], v[216:219]
    v_mfma_f32_16x16x32_bf16 v[220:223], v[200:203], v[184:187], v[220:223]
    s_waitcnt lgkmcnt(0)
    v_mfma_f32_16x16x32_bf16 v[208:211], v[204:207], v[140:143], v[208:211]
    v_mfma_f32_16x16x32_bf16 v[212:215], v[204:207], v[156:159], v[212:215]
    v_mfma_f32_16x16x32_bf16 v[216:219], v[204:207], v[172:175], v[216:219]
    v_mfma_f32_16x16x32_bf16 v[220:223], v[204:207], v[188:191], v[220:223]
    s_nop 4
    v_pk_add_f32 v[208:209], v[208:209], v[210:211]
    v_pk_add_f32 v[212:213], v[212:213], v[214:215]
    v_pk_add_f32 v[216:217], v[216:217], v[218:219]
    v_pk_add_f32 v[220:221], v[220:221], v[222:223]
    v_add_f32 v224, v208, v209
    s_nop 1
    v_add_f32_dpp v224, v212, v213 quad_perm:[0,1,2,3] row_mask:0x2 bank_mask:0xf
    s_nop 1
    v_add_f32_dpp v224, v216, v217 quad_perm:[0,1,2,3] row_mask:0x4 bank_mask:0xf
    s_nop 1
    v_add_f32_dpp v224, v220, v221 quad_perm:[0,1,2,3] row_mask:0x8 bank_mask:0xf
    v_bfi_b32 v224, v229, v228, v224
    global_store_dword v227, v224, s[42:43] sc1
    s_barrier
    s_waitcnt vmcnt(1)
    s_cmp_ge_u32 s2, 224
    s_cbranch_scc1 L_down_s
    s_cmp_ge_u32 s26, 176
    s_cbranch_scc1 L_idle_s
    s_cmp_ge_u32 s2, 64
    s_cbranch_scc1 L_ffn
    s_cmp_ge_u32 s3, 1
    s_cbranch_scc1 L_fin_s
    v_and_b32 v12, 7, v0
    v_lshlrev_b32 v12, 4, v12
    ds_read_b128 v[16:19], v12 offset:512
    ds_read_b128 v[24:27], v12 offset:640
    s_lshl_b32 s4, s2, 7
    s_add_u32 s4, s4, 393216
    v_lshrrev_b32 v14, 3, v0
    v_lshl_add_u32 v13, v14, 13, s4
    v_add_u32 v13, v12, v13
    s_lshl_b32 s4, s2, 13
    s_add_u32 s4, s4, 528384
    v_lshl_add_u32 v14, v0, 4, s4
    v_mov_b32 v20, 0xff
    s_mov_b32 s60, 1048576
Lpoll_89:
    global_load_dwordx4 v[64:67], v14, s[42:43] offset:-4096 sc1
    global_load_dwordx4 v[68:71], v14, s[42:43] offset:-3072 sc1
    global_load_dwordx4 v[72:75], v14, s[42:43] offset:-2048 sc1
    global_load_dwordx4 v[76:79], v14, s[42:43] offset:-1024 sc1
    global_load_dwordx4 v[80:83], v14, s[42:43] offset:0 sc1
    global_load_dwordx4 v[84:87], v14, s[42:43] offset:1024 sc1
    global_load_dwordx4 v[88:91], v14, s[42:43] offset:2048 sc1
    global_load_dwordx4 v[92:95], v14, s[42:43] offset:3072 sc1
    s_waitcnt vmcnt(7)
    v_xor_b32 v64, s98, v64
    v_xor_b32 v65, s99, v65
    v_xor_b32 v66, s100, v66
    v_xor_b32 v67, s101, v67
    s_waitcnt vmcnt(6)
    v_xor_b32 v68, s98, v68
    v_xor_b32 v69, s99, v69
    v_xor_b32 v70, s100, v70
    v_xor_b32 v71, s101, v71
    s_waitcnt vmcnt(5)
    v_xor_b32 v72, s98, v72
    v_xor_b32 v73, s99, v73
    v_xor_b32 v74, s100, v74
    v_xor_b32 v75, s101, v75
    s_waitcnt vmcnt(4)
    v_xor_b32 v76, s98, v76
    v_xor_b32 v77, s99, v77
    v_xor_b32 v78, s100, v78
    v_xor_b32 v79, s101, v79
    s_waitcnt vmcnt(3)
    v_xor_b32 v80, s98, v80
    v_xor_b32 v81, s99, v81
    v_xor_b32 v82, s100, v82
    v_xor_b32 v83, s101, v83
    s_waitcnt vmcnt(2)
    v_xor_b32 v84, s98, v84
    v_xor_b32 v85, s99, v85
    v_xor_b32 v86, s100, v86
    v_xor_b32 v87, s101, v87
    s_waitcnt vmcnt(1)
    v_xor_b32 v88, s98, v88
    v_xor_b32 v89, s99, v89
    v_xor_b32 v90, s100, v90
    v_xor_b32 v91, s101, v91
    s_waitcnt vmcnt(0)
    v_xor_b32 v92, s98, v92
    v_xor_b32 v93, s99, v93
    v_xor_b32 v94, s100, v94
    v_xor_b32 v95, s101, v95
    v_or_b32 v15, v64, v65
    v_or3_b32 v15, v15, v66, v67
    v_or3_b32 v15, v15, v68, v69
    v_or3_b32 v15, v15, v70, v71
    v_or3_b32 v15, v15, v72, v73
    v_or3_b32 v15, v15, v74, v75
    v_or3_b32 v15, v15, v76, v77
    v_or3_b32 v15, v15, v78, v79
    v_or3_b32 v15, v15, v80, v81
    v_or3_b32 v15, v15, v82, v83
    v_or3_b32 v15, v15, v84, v85
    v_or3_b32 v15, v15, v86, v87
    v_or3_b32 v15, v15, v88, v89
    v_or3_b32 v15, v15, v90, v91
    v_or3_b32 v15, v15, v92, v93
    v_or3_b32 v15, v15, v94, v95
    v_and_b32 v15, 0xff, v15
    v_cmp_ne_u32 vcc, 0, v15
    s_nop 0
    s_cmp_eq_u64 vcc, 0
    s_cbranch_scc1 Lpdone_90
    s_sub_u32 s60, s60, 1
    s_cbranch_scc1 Lpdone_90
    s_branch Lpoll_89
Lpdone_90:
    v_pk_add_f32 v[64:65], v[64:65], v[80:81]
    v_pk_add_f32 v[66:67], v[66:67], v[82:83]
    v_pk_add_f32 v[68:69], v[68:69], v[84:85]
    v_pk_add_f32 v[70:71], v[70:71], v[86:87]
    v_pk_add_f32 v[72:73], v[72:73], v[88:89]
    v_pk_add_f32 v[74:75], v[74:75], v[90:91]
    v_pk_add_f32 v[76:77], v[76:77], v[92:93]
    v_pk_add_f32 v[78:79], v[78:79], v[94:95]
    v_pk_add_f32 v[64:65], v[64:65], v[72:73]
    v_pk_add_f32 v[66:67], v[66:67], v[74:75]
    v_pk_add_f32 v[68:69], v[68:69], v[76:77]
    v_pk_add_f32 v[70:71], v[70:71], v[78:79]
    v_pk_add_f32 v[64:65], v[64:65], v[68:69]
    v_pk_add_f32 v[66:67], v[66:67], v[70:71]
    s_nop 0
    v_add_f32_dpp v64, v64, v64 row_ror:8 row_mask:0xf bank_mask:0xf
    v_add_f32_dpp v65, v65, v65 row_ror:8 row_mask:0xf bank_mask:0xf
    v_add_f32_dpp v66, v66, v66 row_ror:8 row_mask:0xf bank_mask:0xf
    v_add_f32_dpp v67, v67, v67 row_ror:8 row_mask:0xf bank_mask:0xf
    v_mov_b32 v68, v64
    v_mov_b32 v69, v65
    v_mov_b32 v70, v66
    v_mov_b32 v71, v67
    v_permlane16_swap_b32 v64, v68
    v_permlane16_swap_b32 v65, v69
    v_permlane16_swap_b32 v66, v70
    v_permlane16_swap_b32 v67, v71
    v_add_f32 v64, v64, v68
    v_add_f32 v65, v65, v69
    v_add_f32 v66, v66, v70
    v_add_f32 v67, v67, v71
    v_mov_b32 v68, v64
    v_mov_b32 v69, v65
    v_mov_b32 v70, v66
    v_mov_b32 v71, v67
    v_permlane32_swap_b32 v64, v68
    v_permlane32_swap_b32 v65, v69
    v_permlane32_swap_b32 v66, v70
    v_permlane32_swap_b32 v67, v71
    v_add_f32 v64, v64, v68
    v_add_f32 v65, v65, v69
    v_add_f32 v66, v66, v70
    v_add_f32 v67, v67, v71
    s_waitcnt lgkmcnt(0)
    v_fma_f32 v64, v16, v64, v24
    v_fma_f32 v65, v17, v65, v25
    v_fma_f32 v66, v18, v66, v26
    v_fma_f32 v67, v19, v67, v27
    v_cvt_pk_bf16_f32 v68, v64, v65
    v_cvt_pk_bf16_f32 v69, v66, v67
    v_lshlrev_b32 v64, 16, v68
    v_and_b32 v65, 0xffff0000, v68
    v_lshlrev_b32 v66, 16, v69
    v_and_b32 v67, 0xffff0000, v69
    v_or_b32 v64, s98, v64
    v_or_b32 v65, s99, v65
    v_or_b32 v66, s100, v66
    v_or_b32 v67, s101, v67
    global_store_dwordx4 v13, v[64:67], s[42:43] sc1
L_fin_s:
    s_endpgm
L_idle_s:
    s_sub_u32 s6, s26, 176
    s_mul_i32 s7, s3, 48
    s_add_u32 s6, s6, s7
    s_cmp_ge_u32 s6, 224
    s_cbranch_scc1 Lpt_91
    s_lshr_b32 s4, s6, 4
    s_lshl_b32 s4, s4, 17
    s_and_b32 s5, s6, 15
    s_lshl_b32 s5, s5, 11
    s_add_u32 s4, s4, s5
    v_and_b32 v14, 15, v0
    v_lshl_add_u32 v14, v14, 7, s4
    v_lshrrev_b32 v13, 4, v0
    v_lshl_add_u32 v14, v13, 15, v14
    global_load_dword v16, v14, s[32:33]
    s_waitcnt vmcnt(0)
Lpt_91:
    s_cmp_lt_u32 s3, 4
    s_cbranch_scc1 L_fin_s
    s_branch L_fin_h
L_ffn:
    s_cmp_lt_u32 s3, 2
    s_cbranch_scc1 L_fin_s
    v_mov_b32 v12, 0
Llw_92:
    ds_read_b32 v13, v12 offset:52
    s_waitcnt lgkmcnt(0)
    v_readfirstlane_b32 s4, v13
    s_nop 0
    s_cmp_ge_u32 s4, 4
    s_cbranch_scc1 Llwd_93
    s_sleep 1
    s_branch Llw_92
Llwd_93:
    v_lshrrev_b32 v13, 4, v0
    v_lshlrev_b32 v14, 9, v13
    v_bfe_u32 v12, v0, 1, 3
    v_lshl_add_u32 v14, v12, 5, v14
    v_and_b32 v12, 1, v0
    v_lshl_add_u32 v14, v12, 3, v14
    s_and_b32 s7, s3, 1
    s_lshl_b32 s4, s7, 4
    s_add_u32 s4, s4, 86016
    v_add_u32 v14, s4, v14
    ds_read_b64_tr_b16 v[64:65], v14 offset:0
    ds_read_b64_tr_b16 v[66:67], v14 offset:256
    ds_read_b64_tr_b16 v[68:69], v14 offset:2048
    ds_read_b64_tr_b16 v[70:71], v14 offset:2304
    ds_read_b64_tr_b16 v[72:73], v14 offset:4096
    ds_read_b64_tr_b16 v[74:75], v14 offset:4352
    ds_read_b64_tr_b16 v[76:77], v14 offset:6144
    ds_read_b64_tr_b16 v[78:79], v14 offset:6400
    s_waitcnt lgkmcnt(0)
    ds_read_b64_tr_b16 v[80:81], v14 offset:8192
    ds_read_b64_tr_b16 v[82:83], v14 offset:8448
    ds_read_b64_tr_b16 v[84:85], v14 offset:10240
    ds_read_b64_tr_b16 v[86:87], v14 offset:10496
    ds_read_b64_tr_b16 v[88:89], v14 offset:12288
    ds_read_b64_tr_b16 v[90:91], v14 offset:12544
    ds_read_b64_tr_b16 v[92:93], v14 offset:14336
    ds_read_b64_tr_b16 v[94:95], v14 offset:14592
    s_waitcnt lgkmcnt(0)
    ds_read_b64_tr_b16 v[96:97], v14 offset:16384
    ds_read_b64_tr_b16 v[98:99], v14 offset:16640
    ds_read_b64_tr_b16 v[100:101], v14 offset:18432
    ds_read_b64_tr_b16 v[102:103], v14 offset:18688
    ds_read_b64_tr_b16 v[104:105], v14 offset:20480
    ds_read_b64_tr_b16 v[106:107], v14 offset:20736
    ds_read_b64_tr_b16 v[108:109], v14 offset:22528
    ds_read_b64_tr_b16 v[110:111], v14 offset:22784
    s_waitcnt lgkmcnt(0)
    ds_read_b64_tr_b16 v[112:113], v14 offset:24576
    ds_read_b64_tr_b16 v[114:115], v14 offset:24832
    ds_read_b64_tr_b16 v[116:117], v14 offset:26624
    ds_read_b64_tr_b16 v[118:119], v14 offset:26880
    ds_read_b64_tr_b16 v[120:121], v14 offset:28672
    ds_read_b64_tr_b16 v[122:123], v14 offset:28928
    ds_read_b64_tr_b16 v[124:125], v14 offset:30720
    ds_read_b64_tr_b16 v[126:127], v14 offset:30976
    s_waitcnt lgkmcnt(0)
    v_and_b32 v15, 3, v0
    v_lshlrev_b32 v15, 10, v15
    v_bfe_u32 v16, v0, 2, 2
    v_lshl_add_u32 v15, v16, 6, v15
    v_lshl_add_u32 v15, v13, 4, v15
    s_sub_u32 s4, s26, 64
    s_lshl_b32 s4, s4, 1
    s_add_u32 s4, s4, s7
    s_lshl_b32 s4, s4, 7
    s_add_u32 s4, s4, 65536
    v_and_b32 v16, 3, v0
    v_lshl_add_u32 v16, v16, 4, s4
    v_bfe_u32 v17, v0, 4, 1
    v_lshl_add_u32 v16, v17, 6, v16
    v_mov_b32 v56, 0xbdd2d3e8
    v_mov_b32 v57, 0xbdd2d3e8
    v_mov_b32 v58, 0xc0135761
    v_mov_b32 v59, 0xc0135761
    v_mov_b32 v60, 1.0
    v_mov_b32 v61, 1.0
    s_mov_b32 s5, 0x3d372713
    s_mov_b32 s6, 0xc0135761
    s_waitcnt lgkmcnt(0)
    s_barrier
    ds_read_b128 v[20:23], v15 offset:14336
    ds_read_b128 v[24:27], v15 offset:14592
    ds_read_b128 v[28:31], v15 offset:14848
    ds_read_b128 v[32:35], v15 offset:15104
    s_waitcnt lgkmcnt(3)
    v_mfma_f32_16x16x32_bf16 v[36:39], v[64:67], v[20:23], 0
    v_mfma_f32_16x16x32_bf16 v[40:43], v[68:71], v[20:23], 0
    v_mfma_f32_16x16x32_bf16 v[44:47], v[72:75], v[20:23], 0
    v_mfma_f32_16x16x32_bf16 v[48:51], v[76:79], v[20:23], 0
    s_waitcnt lgkmcnt(2)
    v_mfma_f32_16x16x32_bf16 v[36:39], v[80:83], v[24:27], v[36:39]
    v_mfma_f32_16x16x32_bf16 v[40:43], v[84:87], v[24:27], v[40:43]
    v_mfma_f32_16x16x32_bf16 v[44:47], v[88:91], v[24:27], v[44:47]
    v_mfma_f32_16x16x32_bf16 v[48:51], v[92:95], v[24:27], v[48:51]
    s_waitcnt lgkmcnt(1)
    v_mfma_f32_16x16x32_bf16 v[36:39], v[96:99], v[28:31], v[36:39]
    v_mfma_f32_16x16x32_bf16 v[40:43], v[100:103], v[28:31], v[40:43]
    v_mfma_f32_16x16x32_bf16 v[44:47], v[104:107], v[28:31], v[44:47]
    v_mfma_f32_16x16x32_bf16 v[48:51], v[108:111], v[28:31], v[48:51]
    s_waitcnt lgkmcnt(0)
    v_mfma_f32_16x16x32_bf16 v[36:39], v[112:115], v[32:35], v[36:39]
    v_mfma_f32_16x16x32_bf16 v[40:43], v[116:119], v[32:35], v[40:43]
    v_mfma_f32_16x16x32_bf16 v[44:47], v[120:123], v[32:35], v[44:47]
    v_mfma_f32_16x16x32_bf16 v[48:51], v[124:127], v[32:35], v[48:51]
    s_nop 5
    v_add_f32_dpp v36, v40, v36 row_shl:4 row_mask:0xf bank_mask:0xf
    v_add_f32_dpp v37, v41, v37 row_shl:4 row_mask:0xf bank_mask:0xf
    v_add_f32_dpp v38, v42, v38 row_shl:4 row_mask:0xf bank_mask:0xf
    v_add_f32_dpp v39, v43, v39 row_shl:4 row_mask:0xf bank_mask:0xf
    v_add_f32_dpp v36, v44, v36 row_shl:8 row_mask:0xf bank_mask:0xf
    v_add_f32_dpp v37, v45, v37 row_shl:8 row_mask:0xf bank_mask:0xf
    v_add_f32_dpp v38, v46, v38 row_shl:8 row_mask:0xf bank_mask:0xf
    v_add_f32_dpp v39, v47, v39 row_shl:8 row_mask:0xf bank_mask:0xf
    v_add_f32_dpp v36, v48, v36 row_shl:12 row_mask:0xf bank_mask:0xf
    v_add_f32_dpp v37, v49, v37 row_shl:12 row_mask:0xf bank_mask:0xf
    v_add_f32_dpp v38, v50, v38 row_shl:12 row_mask:0xf bank_mask:0xf
    v_add_f32_dpp v39, v51, v39 row_shl:12 row_mask:0xf bank_mask:0xf
    v_mov_b32 v40, v36
    v_mov_b32 v41, v37
    v_mov_b32 v42, v38
    v_mov_b32 v43, v39
    v_permlane32_swap_b32 v36, v40
    v_permlane32_swap_b32 v37, v41
    v_permlane32_swap_b32 v38, v42
    v_permlane32_swap_b32 v39, v43
    v_pk_mul_f32 v[44:45], v[36:37], v[36:37]
    v_pk_mul_f32 v[46:47], v[38:39], v[38:39]
    v_pk_fma_f32 v[44:45], v[44:45], v[56:57], v[58:59]
    v_pk_fma_f32 v[46:47], v[46:47], v[56:57], v[58:59]
    v_pk_mul_f32 v[44:45], v[44:45], v[36:37]
    v_pk_mul_f32 v[46:47], v[46:47], v[38:39]
    v_exp_f32 v44, v44
    v_exp_f32 v45, v45
    v_exp_f32 v46, v46
    v_exp_f32 v47, v47
    v_pk_add_f32 v[44:45], v[44:45], v[60:61]
    v_pk_add_f32 v[46:47], v[46:47], v[60:61]
    v_rcp_f32 v44, v44
    v_rcp_f32 v45, v45
    v_rcp_f32 v46, v46
    v_rcp_f32 v47, v47
    v_pk_mul_f32 v[36:37], v[36:37], v[44:45]
    v_pk_mul_f32 v[38:39], v[38:39], v[46:47]
    v_pk_mul_f32 v[36:37], v[36:37], v[40:41]
    v_pk_mul_f32 v[38:39], v[38:39], v[42:43]
    v_cvt_pk_bf16_f32 v52, v36, v37
    v_cvt_pk_bf16_f32 v53, v38, v39
    v_min_u32 v52, -2, v52
    v_min_u32 v53, -2, v53
    v_mov_b32 v54, v52
    v_mov_b32 v55, v53
    s_nop 0
    v_permlane16_swap_b32 v52, v54
    v_permlane16_swap_b32 v53, v55
    s_mov_b32 exec_lo, 0xf000f
    s_mov_b32 exec_hi, 0x0
    global_store_dwordx4 v16, v[52:55], s[42:43] sc1
    s_endpgm
L_down_s:
    s_lshl_b32 s4, s68, 2
    s_add_u32 s4, s4, s69
    s_sub_u32 s4, s4, 28
    s_lshl_b32 s4, s4, 5
    s_mul_i32 s5, s3, 229376
    s_add_u32 s4, s4, s5
    v_lshrrev_b32 v14, 1, v0
    v_lshlrev_b32 v14, 10, v14
    v_and_b32 v13, 1, v0
    v_lshlrev_b32 v13, 4, v13
    v_add3_u32 v14, v14, v13, s4
    s_mul_i32 s6, s3, 7168
    s_add_u32 s6, s6, 86016
    s_and_b32 s7, s69, 3
    s_lshl_b32 s7, s7, 1
    s_lshl_b32 s5, s7, 10
    s_add_u32 m0, s6, s5
    s_lshl_b32 s5, s7, 15
    v_add_u32 v13, s5, v14
    global_load_lds_dwordx4 v13, s[32:33]
    s_add_u32 s7, s7, 1
    s_cmp_eq_u32 s7, 7
    s_cselect_b32 s7, 0, s7
    s_lshl_b32 s5, s7, 10
    s_add_u32 m0, s6, s5
    s_lshl_b32 s5, s7, 15
    v_add_u32 v13, s5, v14
    global_load_lds_dwordx4 v13, s[32:33]
    s_add_u32 s7, s7, 1
    s_cmp_eq_u32 s7, 7
    s_cselect_b32 s7, 0, s7
    s_lshl_b32 s5, s7, 10
    s_add_u32 m0, s6, s5
    s_lshl_b32 s5, s7, 15
    v_add_u32 v13, s5, v14
    global_load_lds_dwordx4 v13, s[32:33]
    s_add_u32 s7, s7, 1
    s_cmp_eq_u32 s7, 7
    s_cselect_b32 s7, 0, s7
    s_lshl_b32 s5, s7, 10
    s_add_u32 m0, s6, s5
    s_lshl_b32 s5, s7, 15
    v_add_u32 v13, s5, v14
    global_load_lds_dwordx4 v13, s[32:33]
    s_add_u32 s7, s7, 1
    s_cmp_eq_u32 s7, 7
    s_cselect_b32 s7, 0, s7
    s_lshl_b32 s5, s7, 10
    s_add_u32 m0, s6, s5
    s_lshl_b32 s5, s7, 15
    v_add_u32 v13, s5, v14
    global_load_lds_dwordx4 v13, s[32:33]
    s_add_u32 s7, s7, 1
    s_cmp_eq_u32 s7, 7
    s_cselect_b32 s7, 0, s7
    s_lshl_b32 s5, s7, 10
    s_add_u32 m0, s6, s5
    s_lshl_b32 s5, s7, 15
    v_add_u32 v13, s5, v14
    global_load_lds_dwordx4 v13, s[32:33]
    s_add_u32 s7, s7, 1
    s_cmp_eq_u32 s7, 7
    s_cselect_b32 s7, 0, s7
    s_lshl_b32 s5, s7, 10
    s_add_u32 m0, s6, s5
    s_lshl_b32 s5, s7, 15
    v_add_u32 v13, s5, v14
    global_load_lds_dwordx4 v13, s[32:33]
    v_and_b32 v12, 15, v0
    v_lshrrev_b32 v13, 4, v0
    v_lshlrev_b32 v14, 8, v13
    v_lshl_add_u32 v14, v12, 3, v14
    s_mul_i32 s4, s3, 7168
    s_add_u32 s4, s4, 86016
    v_add_u32 v14, s4, v14
    s_mul_i32 s4, s3, 7
    v_bfe_u32 v15, v0, 2, 2
    v_add_u32 v15, s4, v15
    v_add_u32 v16, 4, v15
    v_min_u32 v16, 55, v16
    v_and_b32 v17, 3, v0
    v_lshlrev_b32 v18, 4, v17
    v_lshl_add_u32 v18, v13, 6, v18
    ds_read_b128 v[60:63], v18 offset:512
    v_add_u32 v18, 65536, v18
    v_lshl_add_u32 v18, v13, 6, v18
    s_and_b32 s4, s69, 1
    s_lshl_b32 s4, s4, 6
    v_add_u32 v18, s4, v18
    v_lshl_add_u32 v15, v15, 9, v18
    v_lshl_add_u32 v16, v16, 9, v18
    s_lshl_b32 s5, s68, 2
    s_add_u32 s5, s5, s69
    s_sub_u32 s5, s5, 28
    s_lshl_b32 s6, s5, 5
    v_lshl_add_u32 v19, v17, 10, s6
    v_lshl_add_u32 v19, v13, 3, v19
    s_and_b32 s6, s68, 7
    s_lshl_b32 s6, s6, 13
    s_add_u32 s6, s6, 393216
    v_lshl_add_u32 v56, v19, 1, s6
    v_mov_b32 v32, s98
    v_mov_b32 v33, s99
    v_mov_b32 v34, s100
    v_mov_b32 v35, s101
    s_cmp_lg_u32 s3, 0
    s_cbranch_scc1 Lal_94
    global_load_dwordx4 v[32:35], v56, s[42:43] sc1
Lal_94:
    global_load_dwordx4 v[20:23], v15, s[42:43] sc1
    global_load_dwordx4 v[24:27], v16, s[42:43] sc1
    s_waitcnt vmcnt(3)
    s_cmp_eq_u32 s3, 0
    s_cbranch_scc1 L_dw0
    s_waitcnt vmcnt(2)
L_dw0:
    ds_read_b64_tr_b16 v[64:65], v14 offset:0
    ds_read_b64_tr_b16 v[66:67], v14 offset:128
    ds_read_b64_tr_b16 v[68:69], v14 offset:1024
    ds_read_b64_tr_b16 v[70:71], v14 offset:1152
    ds_read_b64_tr_b16 v[72:73], v14 offset:2048
    ds_read_b64_tr_b16 v[74:75], v14 offset:2176
    ds_read_b64_tr_b16 v[76:77], v14 offset:3072
    ds_read_b64_tr_b16 v[78:79], v14 offset:3200
    ds_read_b64_tr_b16 v[80:81], v14 offset:4096
    ds_read_b64_tr_b16 v[82:83], v14 offset:4224
    ds_read_b64_tr_b16 v[84:85], v14 offset:5120
    ds_read_b64_tr_b16 v[86:87], v14 offset:5248
    ds_read_b64_tr_b16 v[88:89], v14 offset:6144
    ds_read_b64_tr_b16 v[90:91], v14 offset:6272
    s_waitcnt vmcnt(0)
    v_max_u32 v57, v20, v21
    v_max3_u32 v57, v57, v22, v23
    v_max3_u32 v57, v57, v24, v25
    v_max3_u32 v57, v57, v26, v27
    v_xor_b32 v28, s98, v32
    v_xor_b32 v29, s99, v33
    v_xor_b32 v30, s100, v34
    v_xor_b32 v31, s101, v35
    v_cmp_eq_u32 s[6:7], -1, v57
    v_or3_b32 v58, v28, v29, v30
    v_or_b32 v58, v58, v31
    v_and_b32 v58, 0xff, v58
    v_cmp_ne_u32 vcc, 0, v58
    s_nop 0
    s_or_b64 vcc, vcc, s[6:7]
    s_cbranch_scc0 L_gotact
    s_mov_b32 s6, 0x1
    s_mov_b32 s7, 0x0
    s_and_b32 s4, s2, 15
    s_lshl_b32 s4, s4, 2
    s_lshl_b64 exec, s[6:7], s4
    s_mov_b32 s60, 1048576
Lpoll_95:
    global_load_dwordx4 v[20:23], v15, s[42:43] offset:0 sc1
    s_waitcnt vmcnt(0)
    v_max_u32 v57, v20, v21
    v_max3_u32 v57, v57, v22, v23
    v_cmp_eq_u32 vcc, -1, v57
    s_nop 0
    s_cmp_eq_u64 vcc, 0
    s_cmp_lg_u64 vcc, exec
    s_cbranch_scc1 Lpdone_96
    s_sub_u32 s60, s60, 1
    s_cbranch_scc1 Lpdone_96
    s_branch Lpoll_95
Lpdone_96:
    s_mov_b64 exec, -1
    s_mov_b32 s60, 1048576
L_actp:
    s_cmp_lg_u32 s3, 0
    s_cbranch_scc1 Lal_97
    global_load_dwordx4 v[32:35], v56, s[42:43] sc1
Lal_97:
    global_load_dwordx4 v[20:23], v15, s[42:43] sc1
    global_load_dwordx4 v[24:27], v16, s[42:43] sc1
    s_waitcnt vmcnt(0)
    v_max_u32 v57, v20, v21
    v_max3_u32 v57, v57, v22, v23
    v_max3_u32 v57, v57, v24, v25
    v_max3_u32 v57, v57, v26, v27
    v_xor_b32 v28, s98, v32
    v_xor_b32 v29, s99, v33
    v_xor_b32 v30, s100, v34
    v_xor_b32 v31, s101, v35
    v_cmp_eq_u32 s[6:7], -1, v57
    v_or3_b32 v58, v28, v29, v30
    v_or_b32 v58, v58, v31
    v_and_b32 v58, 0xff, v58
    v_cmp_ne_u32 vcc, 0, v58
    s_nop 0
    s_or_b64 vcc, vcc, s[6:7]
    s_cbranch_scc0 L_gotact
    s_sub_u32 s60, s60, 1
    s_cbranch_scc0 L_actp
L_gotact:
    s_waitcnt lgkmcnt(0)
    v_mfma_f32_16x16x32_bf16 v[36:39], v[64:67], v[20:23], 0
    v_mfma_f32_16x16x32_bf16 v[40:43], v[68:71], v[20:23], 0
    v_mfma_f32_16x16x32_bf16 v[44:47], v[72:75], v[20:23], 0
    v_mfma_f32_16x16x32_bf16 v[48:51], v[76:79], v[20:23], 0
    v_mfma_f32_16x16x32_bf16 v[36:39], v[80:83], v[24:27], v[36:39]
    v_mfma_f32_16x16x32_bf16 v[40:43], v[84:87], v[24:27], v[40:43]
    v_mfma_f32_16x16x32_bf16 v[44:47], v[88:91], v[24:27], v[44:47]
    s_lshl_b32 s4, s3, 10
    v_lshl_add_u32 v12, v0, 4, s4
    s_nop 3
    v_add_f32_dpp v36, v48, v36 row_shl:12 row_mask:0xf bank_mask:0xf
    v_add_f32_dpp v37, v49, v37 row_shl:12 row_mask:0xf bank_mask:0xf
    v_add_f32_dpp v38, v50, v38 row_shl:12 row_mask:0xf bank_mask:0xf
    v_add_f32_dpp v39, v51, v39 row_shl:12 row_mask:0xf bank_mask:0xf
    v_add_f32_dpp v36, v40, v36 row_shl:4 row_mask:0xf bank_mask:0xf
    v_add_f32_dpp v37, v41, v37 row_shl:4 row_mask:0xf bank_mask:0xf
    v_add_f32_dpp v38, v42, v38 row_shl:4 row_mask:0xf bank_mask:0xf
    v_add_f32_dpp v39, v43, v39 row_shl:4 row_mask:0xf bank_mask:0xf
    v_add_f32_dpp v36, v44, v36 row_shl:8 row_mask:0xf bank_mask:0xf
    v_add_f32_dpp v37, v45, v37 row_shl:8 row_mask:0xf bank_mask:0xf
    v_add_f32_dpp v38, v46, v38 row_shl:8 row_mask:0xf bank_mask:0xf
    v_add_f32_dpp v39, v47, v39 row_shl:8 row_mask:0xf bank_mask:0xf
    ds_write_b128 v12, v[36:39] offset:2048
    s_waitcnt lgkmcnt(0)
    s_barrier
    s_cmp_eq_u32 s3, 4
    s_cbranch_scc1 L_epoch
    s_cmp_lg_u32 s3, 0
    s_cbranch_scc1 L_fin_d
    ds_read_b128 v[68:71], v12 offset:3072
    ds_read_b128 v[72:75], v12 offset:4096
    ds_read_b128 v[76:79], v12 offset:5120
    ds_read_b128 v[80:83], v12 offset:6144
    ds_read_b128 v[84:87], v12 offset:7168
    ds_read_b128 v[88:91], v12 offset:8192
    ds_read_b128 v[92:95], v12 offset:9216
    s_waitcnt lgkmcnt(0)
    v_pk_add_f32 v[64:65], v[36:37], v[68:69]
    v_pk_add_f32 v[66:67], v[38:39], v[70:71]
    v_pk_add_f32 v[72:73], v[72:73], v[76:77]
    v_pk_add_f32 v[74:75], v[74:75], v[78:79]
    v_pk_add_f32 v[80:81], v[80:81], v[84:85]
    v_pk_add_f32 v[82:83], v[82:83], v[86:87]
    v_pk_add_f32 v[88:89], v[88:89], v[92:93]
    v_pk_add_f32 v[90:91], v[90:91], v[94:95]
    v_pk_add_f32 v[64:65], v[64:65], v[72:73]
    v_pk_add_f32 v[66:67], v[66:67], v[74:75]
    v_pk_add_f32 v[80:81], v[80:81], v[88:89]
    v_pk_add_f32 v[82:83], v[82:83], v[90:91]
    v_pk_add_f32 v[64:65], v[64:65], v[80:81]
    v_pk_add_f32 v[66:67], v[66:67], v[82:83]
    v_fma_f32 v64, v60, v64, v28
    v_fma_f32 v65, v61, v65, v29
    v_fma_f32 v66, v62, v66, v30
    v_fma_f32 v67, v63, v67, v31
    v_cvt_pk_bf16_f32 v68, v64, v65
    v_cvt_pk_bf16_f32 v69, v66, v67
    s_mov_b32 exec_lo, 0xf000f
    s_mov_b32 exec_hi, 0xf000f
    global_store_dwordx2 v19, v[68:69], s[38:39]
L_fin_d:
    s_endpgm
L_epoch:
    s_cmp_lg_u32 s2, 224
    s_cbranch_scc1 L_fin_d
    v_mov_b32 v12, 0
    v_mov_b32 v13, s14
    s_mov_b64 exec, 1
    global_store_dword v12, v13, s[42:43]
    s_branch L_fin_d
L_helper:
    v_and_b32 v1, 15, v0
    v_lshrrev_b32 v2, 4, v0
    v_mov_b32 v3, 0xff
    s_lshl_b32 s10, s61, 12
    s_and_b32 s9, s68, 3
    s_xor_b32 s9, s9, s69
    s_cmp_ge_u32 s2, 128
    s_cbranch_scc1 L_t1
    s_and_b32 s12, s2, 3
    s_lshr_b32 s4, s2, 2
    s_lshr_b32 s5, s4, 1
    s_lshl_b32 s5, s5, 2
    s_and_b32 s6, s4, 1
    s_add_u32 s5, s5, s6
    s_lshl_b32 s11, s4, 2
    s_sub_u32 s11, s11, 78
    s_cmp_lt_u32 s4, 24
    s_cselect_b32 s11, s5, s11
    s_branch L_t2
L_t1:
    s_and_b32 s12, s59, 3
    s_and_b32 s4, s59, 60
    s_add_u32 s5, s4, 3
    s_sub_u32 s11, s4, 46
    s_cmp_lt_u32 s4, 48
    s_cselect_b32 s11, s5, s11
    s_bitcmp1_b32 s9, 0
    s_cselect_b32 s11, 48, s11
L_t2:
    s_lshl_b32 s13, s12, 7
    s_lshl_b32 s4, s61, 5
    s_add_u32 s13, s13, s4
    v_lshrrev_b32 v14, 3, v0
    v_add_u32 v14, s13, v14
    v_mul_u32_u24 v14, 6144, v14
    v_and_b32 v15, 7, v0
    v_lshlrev_b32 v15, 4, v15
    s_lshl_b32 s4, s11, 7
    v_add3_u32 v14, v14, v15, s4
    v_and_b32 v15, 3, v0
    v_lshlrev_b32 v15, 10, v15
    v_lshl_add_u32 v15, v2, 4, v15
    s_lshl_b32 s4, s13, 1
    v_add_u32 v15, s4, v15
    s_lshl_b32 s4, s68, 6
    s_lshl_b32 s5, s61, 4
    s_add_u32 s4, s4, s5
    s_lshl_b32 s4, s4, 13
    s_lshl_b32 s5, s9, 8
    s_add_u32 s4, s4, s5
    v_lshl_add_u32 v16, v2, 13, s4
    v_lshl_add_u32 v16, v1, 4, v16
    s_lshl_b32 s4, s61, 10
    v_lshl_add_u32 v17, v0, 4, s4
    s_waitcnt lgkmcnt(0)
    s_load_dword s14, s[42:43], 0
    s_cmp_ge_u32 s11, 48
    s_cbranch_scc1 L_nomod1
    global_load_dwordx4 v[20:23], v15, s[34:35]
    s_add_u32 m0, s10, 20480
    s_nop 0
    global_load_lds_dwordx4 v14, s[36:37] nt
    v_add_u32 v14, 49152, v14
    s_add_u32 m0, s10, 21504
    s_nop 0
    global_load_lds_dwordx4 v14, s[36:37] nt
    v_add_u32 v14, 49152, v14
    s_add_u32 m0, s10, 22528
    s_nop 0
    global_load_lds_dwordx4 v14, s[36:37] nt
    v_add_u32 v14, 49152, v14
    s_add_u32 m0, s10, 23552
    s_nop 0
    global_load_lds_dwordx4 v14, s[36:37] nt
L_nomod1:
    global_load_dwordx4 v[24:27], v17, s[16:17]
    s_add_u32 m0, s10, 36864
    s_nop 0
    global_load_lds_dwordx4 v16, s[22:23] nt
    v_add_u32 v16, 32768, v16
    s_add_u32 m0, s10, 37888
    s_nop 0
    global_load_lds_dwordx4 v16, s[22:23] nt
    v_add_u32 v16, 32768, v16
    s_add_u32 m0, s10, 38912
    s_nop 0
    global_load_lds_dwordx4 v16, s[22:23] nt
    v_add_u32 v16, 32768, v16
    s_add_u32 m0, s10, 39936
    s_nop 0
    global_load_lds_dwordx4 v16, s[22:23] nt
    s_barrier
    s_waitcnt lgkmcnt(0)
    s_lshr_b32 s4, s68, 1
    s_and_b32 s5, s68, 1
    s_mul_i32 s6, s4, 28
    s_lshl_b32 s7, s5, 4
    s_add_u32 s6, s6, s7
    s_add_u32 s6, s6, s69
    s_add_u32 s6, s6, 56
    s_mul_i32 s4, s4, 12
    s_lshl_b32 s7, s5, 3
    s_add_u32 s4, s4, s7
    s_add_u32 s4, s4, s69
    s_add_u32 s4, s4, 152
    s_lshl_b32 s5, s5, 2
    s_add_u32 s5, s5, s69
    s_cmp_lt_u32 s5, 24
    s_cselect_b32 s26, s6, s4
    s_cmp_lt_u32 s2, 64
    s_cselect_b32 s26, s2, s26
    s_cmp_ge_u32 s2, 224
    s_cselect_b32 s26, s2, s26
    s_add_u32 s14, s14, 0x9e3779b1
    s_bfe_u32 s98, s14, 0x80000
    s_bfe_u32 s99, s14, 0x80008
    s_bfe_u32 s100, s14, 0x80010
    s_bfe_u32 s101, s14, 0x80018
    s_cmp_ge_u32 s11, 48
    s_cbranch_scc1 L_nomod2
    s_waitcnt vmcnt(9)
    v_lshlrev_b32 v28, 16, v20
    v_and_b32 v29, 0xffff0000, v20
    v_lshlrev_b32 v30, 16, v21
    v_and_b32 v31, 0xffff0000, v21
    v_lshlrev_b32 v32, 16, v22
    v_and_b32 v33, 0xffff0000, v22
    v_lshlrev_b32 v34, 16, v23
    v_and_b32 v35, 0xffff0000, v23
    v_mul_f32 v36, 0xbfb8aa3b, v28
    v_mul_f32 v37, 0xbfb8aa3b, v29
    v_mul_f32 v38, 0xbfb8aa3b, v30
    v_mul_f32 v39, 0xbfb8aa3b, v31
    v_mul_f32 v40, 0xbfb8aa3b, v32
    v_mul_f32 v41, 0xbfb8aa3b, v33
    v_mul_f32 v42, 0xbfb8aa3b, v34
    v_mul_f32 v43, 0xbfb8aa3b, v35
    v_exp_f32 v36, v36
    v_exp_f32 v37, v37
    v_exp_f32 v38, v38
    v_exp_f32 v39, v39
    v_exp_f32 v40, v40
    v_exp_f32 v41, v41
    v_exp_f32 v42, v42
    v_exp_f32 v43, v43
    v_add_f32 v36, 1.0, v36
    v_add_f32 v37, 1.0, v37
    v_add_f32 v38, 1.0, v38
    v_add_f32 v39, 1.0, v39
    v_add_f32 v40, 1.0, v40
    v_add_f32 v41, 1.0, v41
    v_add_f32 v42, 1.0, v42
    v_add_f32 v43, 1.0, v43
    v_rcp_f32 v44, v36
    v_rcp_f32 v45, v37
    v_rcp_f32 v46, v38
    v_rcp_f32 v47, v39
    v_rcp_f32 v48, v40
    v_rcp_f32 v49, v41
    v_rcp_f32 v50, v42
    v_rcp_f32 v51, v43
    v_mul_f32 v52, v28, v44
    v_mul_f32 v53, v29, v45
    v_mul_f32 v54, v30, v46
    v_mul_f32 v55, v31, v47
    v_mul_f32 v56, v32, v48
    v_mul_f32 v57, v33, v49
    v_mul_f32 v58, v34, v50
    v_mul_f32 v59, v35, v51
    v_fma_f32 v28, -v52, v36, v28
    v_fma_f32 v29, -v53, v37, v29
    v_fma_f32 v30, -v54, v38, v30
    v_fma_f32 v31, -v55, v39, v31
    v_fma_f32 v32, -v56, v40, v32
    v_fma_f32 v33, -v57, v41, v33
    v_fma_f32 v34, -v58, v42, v34
    v_fma_f32 v35, -v59, v43, v35
    v_fma_f32 v28, v28, v44, v52
    v_fma_f32 v29, v29, v45, v53
    v_fma_f32 v30, v30, v46, v54
    v_fma_f32 v31, v31, v47, v55
    v_fma_f32 v32, v32, v48, v56
    v_fma_f32 v33, v33, v49, v57
    v_fma_f32 v34, v34, v50, v58
    v_fma_f32 v35, v35, v51, v59
    v_cmp_u_f32 vcc, v28, v28
    s_nop 1
    v_cndmask_b32 v28, v28, v52, vcc
    v_cmp_u_f32 vcc, v29, v29
    s_nop 1
    v_cndmask_b32 v29, v29, v53, vcc
    v_cmp_u_f32 vcc, v30, v30
    s_nop 1
    v_cndmask_b32 v30, v30, v54, vcc
    v_cmp_u_f32 vcc, v31, v31
    s_nop 1
    v_cndmask_b32 v31, v31, v55, vcc
    v_cmp_u_f32 vcc, v32, v32
    s_nop 1
    v_cndmask_b32 v32, v32, v56, vcc
    v_cmp_u_f32 vcc, v33, v33
    s_nop 1
    v_cndmask_b32 v33, v33, v57, vcc
    v_cmp_u_f32 vcc, v34, v34
    s_nop 1
    v_cndmask_b32 v34, v34, v58, vcc
    v_cmp_u_f32 vcc, v35, v35
    s_nop 1
    v_cndmask_b32 v35, v35, v59, vcc
    v_cvt_pk_bf16_f32 v20, v28, v29
    v_cvt_pk_bf16_f32 v21, v30, v31
    v_cvt_pk_bf16_f32 v22, v32, v33
    v_cvt_pk_bf16_f32 v23, v34, v35
    v_lshlrev_b32 v14, 10, v2
    v_bfe_u32 v15, v0, 2, 2
    v_lshl_add_u32 v14, v15, 7, v14
    v_and_b32 v15, 3, v0
    v_lshl_add_u32 v14, v15, 3, v14
    v_add_u32 v14, s10, v14
    s_waitcnt vmcnt(5)
    ds_read_b64_tr_b16 v[64:65], v14 offset:20480
    ds_read_b64_tr_b16 v[66:67], v14 offset:20992
    ds_read_b64_tr_b16 v[68:69], v14 offset:20512
    ds_read_b64_tr_b16 v[70:71], v14 offset:21024
    ds_read_b64_tr_b16 v[72:73], v14 offset:20544
    ds_read_b64_tr_b16 v[74:75], v14 offset:21056
    ds_read_b64_tr_b16 v[76:77], v14 offset:20576
    ds_read_b64_tr_b16 v[78:79], v14 offset:21088
    s_waitcnt lgkmcnt(6)
    v_mfma_f32_16x16x32_bf16 v[36:39], v[64:67], v[20:23], 0
    s_waitcnt lgkmcnt(4)
    v_mfma_f32_16x16x32_bf16 v[40:43], v[68:71], v[20:23], 0
    s_waitcnt lgkmcnt(2)
    v_mfma_f32_16x16x32_bf16 v[44:47], v[72:75], v[20:23], 0
    s_waitcnt lgkmcnt(0)
    v_mfma_f32_16x16x32_bf16 v[48:51], v[76:79], v[20:23], 0
    s_nop 3
    v_mov_b32_dpp v36, v40 quad_perm:[0,1,2,3] row_mask:0xf bank_mask:0x2
    v_mov_b32_dpp v37, v41 quad_perm:[0,1,2,3] row_mask:0xf bank_mask:0x2
    v_mov_b32_dpp v38, v42 quad_perm:[0,1,2,3] row_mask:0xf bank_mask:0x2
    v_mov_b32_dpp v39, v43 quad_perm:[0,1,2,3] row_mask:0xf bank_mask:0x2
    v_mov_b32_dpp v36, v44 quad_perm:[0,1,2,3] row_mask:0xf bank_mask:0x4
    v_mov_b32_dpp v37, v45 quad_perm:[0,1,2,3] row_mask:0xf bank_mask:0x4
    v_mov_b32_dpp v38, v46 quad_perm:[0,1,2,3] row_mask:0xf bank_mask:0x4
    v_mov_b32_dpp v39, v47 quad_perm:[0,1,2,3] row_mask:0xf bank_mask:0x4
    v_mov_b32_dpp v36, v48 quad_perm:[0,1,2,3] row_mask:0xf bank_mask:0x8
    v_mov_b32_dpp v37, v49 quad_perm:[0,1,2,3] row_mask:0xf bank_mask:0x8
    v_mov_b32_dpp v38, v50 quad_perm:[0,1,2,3] row_mask:0xf bank_mask:0x8
    v_mov_b32_dpp v39, v51 quad_perm:[0,1,2,3] row_mask:0xf bank_mask:0x8
    s_lshl_b32 s4, s61, 10
    v_lshl_add_u32 v12, v0, 4, s4
    ds_write_b128 v12, v[36:39] offset:2048
    v_mov_b32 v12, 0
    v_mov_b32 v13, 1
    s_waitcnt lgkmcnt(0)
    s_mov_b64 exec, 1
    ds_add_rtn_u32 v13, v12, v13 offset:0
    s_waitcnt lgkmcnt(0)
    v_readfirstlane_b32 s4, v13
    s_mov_b64 exec, -1
    s_cmp_lg_u32 s4, 3
    s_cbranch_scc1 L_nomod2
    v_lshlrev_b32 v12, 4, v0
    ds_read_b128 v[36:39], v12 offset:2048
    ds_read_b128 v[40:43], v12 offset:3072
    ds_read_b128 v[44:47], v12 offset:4096
    ds_read_b128 v[48:51], v12 offset:5120
    s_cmp_lt_u32 s11, 16
    s_cbranch_scc1 L_modp
    s_sub_u32 s4, s11, 16
    s_lshr_b32 s5, s4, 3
    s_lshl_b32 s5, s5, 15
    s_and_b32 s4, s4, 7
    s_lshl_b32 s4, s4, 8
    s_add_u32 s4, s4, s5
    s_lshl_b32 s5, s12, 13
    s_add_u32 s4, s4, s5
    s_add_u32 s4, s4, 196608
    v_and_b32 v12, 3, v0
    v_lshl_add_u32 v12, v12, 11, s4
    v_bfe_u32 v13, v0, 2, 2
    v_lshl_add_u32 v12, v13, 6, v12
    v_lshl_add_u32 v12, v2, 4, v12
    s_branch L_modst
L_modp:
    s_and_b32 s4, s11, 7
    s_lshl_b32 s4, s4, 13
    s_lshl_b32 s5, s12, 11
    s_add_u32 s4, s4, s5
    s_lshr_b32 s5, s11, 3
    s_lshl_b32 s5, s5, 7
    s_add_u32 s4, s4, s5
    s_add_u32 s4, s4, 131072
    v_and_b32 v12, 3, v0
    v_lshl_add_u32 v12, v12, 4, s4
    v_bfe_u32 v13, v0, 4, 1
    v_lshl_add_u32 v12, v13, 10, v12
    v_bfe_u32 v13, v0, 2, 1
    v_lshl_add_u32 v12, v13, 9, v12
    v_lshrrev_b32 v13, 5, v0
    v_lshl_add_u32 v12, v13, 8, v12
    v_bfe_u32 v13, v0, 3, 1
    v_lshl_add_u32 v12, v13, 6, v12
L_modst:
    s_waitcnt lgkmcnt(0)
    v_pk_add_f32 v[36:37], v[36:37], v[44:45]
    v_pk_add_f32 v[38:39], v[38:39], v[46:47]
    v_pk_add_f32 v[40:41], v[40:41], v[48:49]
    v_pk_add_f32 v[42:43], v[42:43], v[50:51]
    v_pk_add_f32 v[36:37], v[36:37], v[40:41]
    v_pk_add_f32 v[38:39], v[38:39], v[42:43]
    v_add_u32 v36, 0x80, v36
    v_add_u32 v37, 0x80, v37
    v_add_u32 v38, 0x80, v38
    v_add_u32 v39, 0x80, v39
    v_bfi_b32 v36, v3, s98, v36
    v_bfi_b32 v37, v3, s99, v37
    v_bfi_b32 v38, v3, s100, v38
    v_bfi_b32 v39, v3, s101, v39
    global_store_dwordx4 v12, v[36:39], s[42:43] sc1
    s_waitcnt vmcnt(1)
    s_branch L_ln
L_nomod2:
    s_waitcnt vmcnt(0)
L_ln:
    v_lshlrev_b32 v28, 16, v24
    v_and_b32 v29, 0xffff0000, v24
    v_lshlrev_b32 v30, 16, v25
    v_and_b32 v31, 0xffff0000, v25
    v_lshlrev_b32 v32, 16, v26
    v_and_b32 v33, 0xffff0000, v26
    v_lshlrev_b32 v34, 16, v27
    v_and_b32 v35, 0xffff0000, v27
    v_add_f32 v36, v28, v29
    v_add_f32 v37, v30, v31
    v_add_f32 v38, v32, v33
    v_add_f32 v39, v34, v35
    v_add_f32 v36, v36, v37
    v_add_f32 v38, v38, v39
    v_add_f32 v36, v36, v38
    s_nop 1
    v_add_f32_dpp v36, v36, v36 row_ror:8 row_mask:0xf bank_mask:0xf
    s_nop 1
    v_add_f32_dpp v36, v36, v36 row_ror:4 row_mask:0xf bank_mask:0xf
    s_nop 1
    v_add_f32_dpp v36, v36, v36 row_ror:2 row_mask:0xf bank_mask:0xf
    s_nop 1
    v_add_f32_dpp v36, v36, v36 row_ror:1 row_mask:0xf bank_mask:0xf
    v_mov_b32 v37, v36
    s_nop 1
    v_permlane16_swap_b32 v36, v37
    v_add_f32 v36, v36, v37
    v_mov_b32 v37, v36
    s_nop 1
    v_permlane32_swap_b32 v36, v37
    v_add_f32 v36, v36, v37
    v_mul_f32 v36, 0x3b000000, v36
    v_sub_f32 v40, v28, v36
    v_sub_f32 v41, v29, v36
    v_sub_f32 v42, v30, v36
    v_sub_f32 v43, v31, v36
    v_sub_f32 v44, v32, v36
    v_sub_f32 v45, v33, v36
    v_sub_f32 v46, v34, v36
    v_sub_f32 v47, v35, v36
    v_mul_f32 v37, v40, v40
    v_fmac_f32 v37, v41, v41
    v_fmac_f32 v37, v42, v42
    v_fmac_f32 v37, v43, v43
    v_fmac_f32 v37, v44, v44
    v_fmac_f32 v37, v45, v45
    v_fmac_f32 v37, v46, v46
    v_fmac_f32 v37, v47, v47
    s_nop 1
    v_add_f32_dpp v37, v37, v37 row_ror:8 row_mask:0xf bank_mask:0xf
    s_nop 1
    v_add_f32_dpp v37, v37, v37 row_ror:4 row_mask:0xf bank_mask:0xf
    s_nop 1
    v_add_f32_dpp v37, v37, v37 row_ror:2 row_mask:0xf bank_mask:0xf
    s_nop 1
    v_add_f32_dpp v37, v37, v37 row_ror:1 row_mask:0xf bank_mask:0xf
    v_mov_b32 v38, v37
    s_nop 1
    v_permlane16_swap_b32 v37, v38
    v_add_f32 v37, v37, v38
    v_mov_b32 v38, v37
    s_nop 1
    v_permlane32_swap_b32 v37, v38
    v_add_f32 v37, v37, v38
    v_mul_f32 v37, 0x3b000000, v37
    v_cvt_pk_bf16_f32 v38, v36, v37
    v_lshlrev_b32 v36, 16, v38
    v_and_b32 v37, 0xffff0000, v38
    v_add_f32 v37, 0x3727c5ac, v37
    v_cvt_pk_bf16_f32 v37, v37, v37
    v_and_b32 v37, 0xffff0000, v37
    v_sqrt_f32 v37, v37
    s_nop 0
    v_cvt_pk_bf16_f32 v37, v37, v37
    v_and_b32 v37, 0xffff0000, v37
    v_rcp_f32 v38, v37
    v_sub_f32 v28, v28, v36
    v_sub_f32 v29, v29, v36
    v_sub_f32 v30, v30, v36
    v_sub_f32 v31, v31, v36
    v_sub_f32 v32, v32, v36
    v_sub_f32 v33, v33, v36
    v_sub_f32 v34, v34, v36
    v_sub_f32 v35, v35, v36
    v_cvt_pk_bf16_f32 v48, v28, v29
    v_cvt_pk_bf16_f32 v49, v30, v31
    v_cvt_pk_bf16_f32 v50, v32, v33
    v_cvt_pk_bf16_f32 v51, v34, v35
    v_lshlrev_b32 v28, 16, v48
    v_and_b32 v29, 0xffff0000, v48
    v_lshlrev_b32 v30, 16, v49
    v_and_b32 v31, 0xffff0000, v49
    v_lshlrev_b32 v32, 16, v50
    v_and_b32 v33, 0xffff0000, v50
    v_lshlrev_b32 v34, 16, v51
    v_and_b32 v35, 0xffff0000, v51
    v_mul_f32 v40, v28, v38
    v_mul_f32 v41, v29, v38
    v_mul_f32 v42, v30, v38
    v_mul_f32 v43, v31, v38
    v_mul_f32 v44, v32, v38
    v_mul_f32 v45, v33, v38
    v_mul_f32 v46, v34, v38
    v_mul_f32 v47, v35, v38
    v_fma_f32 v28, -v40, v37, v28
    v_fma_f32 v29, -v41, v37, v29
    v_fma_f32 v30, -v42, v37, v30
    v_fma_f32 v31, -v43, v37, v31
    v_fma_f32 v32, -v44, v37, v32
    v_fma_f32 v33, -v45, v37, v33
    v_fma_f32 v34, -v46, v37, v34
    v_fma_f32 v35, -v47, v37, v35
    v_fma_f32 v40, v28, v38, v40
    v_fma_f32 v41, v29, v38, v41
    v_fma_f32 v42, v30, v38, v42
    v_fma_f32 v43, v31, v38, v43
    v_fma_f32 v44, v32, v38, v44
    v_fma_f32 v45, v33, v38, v45
    v_fma_f32 v46, v34, v38, v46
    v_fma_f32 v47, v35, v38, v47
    v_cvt_pk_bf16_f32 v48, v40, v41
    v_cvt_pk_bf16_f32 v49, v42, v43
    v_cvt_pk_bf16_f32 v50, v44, v45
    v_cvt_pk_bf16_f32 v51, v46, v47
    v_lshlrev_b32 v40, 16, v48
    v_and_b32 v41, 0xffff0000, v48
    v_lshlrev_b32 v42, 16, v49
    v_and_b32 v43, 0xffff0000, v49
    v_lshlrev_b32 v44, 16, v50
    v_and_b32 v45, 0xffff0000, v50
    v_lshlrev_b32 v46, 16, v51
    v_and_b32 v47, 0xffff0000, v51
    s_lshl_b32 s4, s61, 8
    v_and_b32 v12, 7, v0
    v_lshl_add_u32 v12, v12, 5, s4
    s_lshl_b32 s4, s68, 3
    s_lshl_b64 exec, 0xff, s4
    ds_write_b128 v12, v[40:43] offset:1024
    ds_write_b128 v12, v[44:47] offset:1040
    s_mov_b64 exec, 1
    v_mov_b32 v12, 0
    v_mov_b32 v13, 1
    s_waitcnt lgkmcnt(0)
    ds_add_u32 v12, v13 offset:4
    s_mov_b64 exec, -1
    s_cmp_lg_u32 s61, 0
    s_cbranch_scc1 L_noq
    v_mov_b32 v12, 0
Llw_98:
    ds_read_b32 v13, v12 offset:4
    s_waitcnt lgkmcnt(0)
    v_readfirstlane_b32 s4, v13
    s_nop 0
    s_cmp_ge_u32 s4, 4
    s_cbranch_scc1 Llwd_99
    s_sleep 1
    s_branch Llw_98
Llwd_99:
    v_lshlrev_b32 v14, 11, v2
    v_bfe_u32 v15, v0, 2, 2
    v_lshl_add_u32 v14, v15, 8, v14
    v_and_b32 v15, 3, v0
    v_lshl_add_u32 v14, v15, 3, v14
    v_add_u32 v14, 36864, v14
    ds_read_b64_tr_b16 v[128:129], v14 offset:0
    ds_read_b64_tr_b16 v[130:131], v14 offset:1024
    ds_read_b64_tr_b16 v[132:133], v14 offset:8192
    ds_read_b64_tr_b16 v[134:135], v14 offset:9216
    ds_read_b64_tr_b16 v[136:137], v14 offset:32
    ds_read_b64_tr_b16 v[138:139], v14 offset:1056
    ds_read_b64_tr_b16 v[140:141], v14 offset:8224
    ds_read_b64_tr_b16 v[142:143], v14 offset:9248
    s_waitcnt lgkmcnt(0)
    ds_read_b64_tr_b16 v[144:145], v14 offset:64
    ds_read_b64_tr_b16 v[146:147], v14 offset:1088
    ds_read_b64_tr_b16 v[148:149], v14 offset:8256
    ds_read_b64_tr_b16 v[150:151], v14 offset:9280
    ds_read_b64_tr_b16 v[152:153], v14 offset:96
    ds_read_b64_tr_b16 v[154:155], v14 offset:1120
    ds_read_b64_tr_b16 v[156:157], v14 offset:8288
    ds_read_b64_tr_b16 v[158:159], v14 offset:9312
    s_waitcnt lgkmcnt(0)
    ds_read_b64_tr_b16 v[160:161], v14 offset:128
    ds_read_b64_tr_b16 v[162:163], v14 offset:1152
    ds_read_b64_tr_b16 v[164:165], v14 offset:8320
    ds_read_b64_tr_b16 v[166:167], v14 offset:9344
    ds_read_b64_tr_b16 v[168:169], v14 offset:160
    ds_read_b64_tr_b16 v[170:171], v14 offset:1184
    ds_read_b64_tr_b16 v[172:173], v14 offset:8352
    ds_read_b64_tr_b16 v[174:175], v14 offset:9376
    s_waitcnt lgkmcnt(0)
    ds_read_b64_tr_b16 v[176:177], v14 offset:192
    ds_read_b64_tr_b16 v[178:179], v14 offset:1216
    ds_read_b64_tr_b16 v[180:181], v14 offset:8384
    ds_read_b64_tr_b16 v[182:183], v14 offset:9408
    ds_read_b64_tr_b16 v[184:185], v14 offset:224
    ds_read_b64_tr_b16 v[186:187], v14 offset:1248
    ds_read_b64_tr_b16 v[188:189], v14 offset:8416
    ds_read_b64_tr_b16 v[190:191], v14 offset:9440
    s_waitcnt lgkmcnt(0)
    v_lshlrev_b32 v15, 8, v15
    v_bfe_u32 v13, v0, 2, 1
    v_lshl_add_u32 v15, v13, 7, v15
    v_lshl_add_u32 v15, v2, 5, v15
    ds_read_b128 v[28:31], v15 offset:1024
    ds_read_b128 v[32:35], v15 offset:1040
    s_lshl_b32 s4, s68, 13
    s_add_u32 s4, s4, 135168
    v_lshl_add_u32 v14, v0, 4, s4
    s_lshr_b32 s4, s9, 3
    s_lshl_b32 s4, s4, 17
    s_and_b32 s5, s9, 7
    s_lshl_b32 s5, s5, 12
    s_add_u32 s4, s4, s5
    s_lshl_b32 s5, s68, 9
    s_add_u32 s4, s4, s5
    s_add_u32 s4, s4, 1048576
    v_and_b32 v16, 3, v0
    v_lshl_add_u32 v16, v16, 15, s4
    v_bfe_u32 v13, v0, 2, 2
    v_lshl_add_u32 v16, v13, 6, v16
    v_lshl_add_u32 v16, v2, 4, v16
    s_lshr_b32 s4, s57, 3
    s_lshl_b32 s4, s4, 17
    s_and_b32 s5, s57, 7
    s_lshl_b32 s5, s5, 12
    s_add_u32 s4, s4, s5
    s_lshl_b32 s5, s56, 15
    s_add_u32 s4, s4, s5
    s_add_u32 s4, s4, 1048576
    v_lshl_add_u32 v17, v0, 4, s4
    v_mov_b32 v18, 1.0
    v_mov_b32 v12, 0
Llw_100:
    ds_read_b32 v13, v12 offset:60
    s_waitcnt lgkmcnt(0)
    v_readfirstlane_b32 s4, v13
    s_nop 0
    s_cmp_ge_u32 s4, 1
    s_cbranch_scc1 Llwd_101
    s_sleep 2
    s_branch Llw_100
Llwd_101:
    s_mov_b32 s60, 1048576
Lpoll_102:
    global_load_dwordx4 v[64:67], v14, s[42:43] offset:-4096 sc1
    global_load_dwordx4 v[68:71], v14, s[42:43] offset:-3072 sc1
    global_load_dwordx4 v[72:75], v14, s[42:43] offset:-2048 sc1
    global_load_dwordx4 v[76:79], v14, s[42:43] offset:-1024 sc1
    global_load_dwordx4 v[80:83], v14, s[42:43] offset:0 sc1
    global_load_dwordx4 v[84:87], v14, s[42:43] offset:1024 sc1
    global_load_dwordx4 v[88:91], v14, s[42:43] offset:2048 sc1
    global_load_dwordx4 v[92:95], v14, s[42:43] offset:3072 sc1
    s_waitcnt vmcnt(7)
    v_xor_b32 v64, s98, v64
    v_xor_b32 v65, s99, v65
    v_xor_b32 v66, s100, v66
    v_xor_b32 v67, s101, v67
    s_waitcnt vmcnt(6)
    v_xor_b32 v68, s98, v68
    v_xor_b32 v69, s99, v69
    v_xor_b32 v70, s100, v70
    v_xor_b32 v71, s101, v71
    s_waitcnt vmcnt(5)
    v_xor_b32 v72, s98, v72
    v_xor_b32 v73, s99, v73
    v_xor_b32 v74, s100, v74
    v_xor_b32 v75, s101, v75
    s_waitcnt vmcnt(4)
    v_xor_b32 v76, s98, v76
    v_xor_b32 v77, s99, v77
    v_xor_b32 v78, s100, v78
    v_xor_b32 v79, s101, v79
    s_waitcnt vmcnt(3)
    v_xor_b32 v80, s98, v80
    v_xor_b32 v81, s99, v81
    v_xor_b32 v82, s100, v82
    v_xor_b32 v83, s101, v83
    s_waitcnt vmcnt(2)
    v_xor_b32 v84, s98, v84
    v_xor_b32 v85, s99, v85
    v_xor_b32 v86, s100, v86
    v_xor_b32 v87, s101, v87
    s_waitcnt vmcnt(1)
    v_xor_b32 v88, s98, v88
    v_xor_b32 v89, s99, v89
    v_xor_b32 v90, s100, v90
    v_xor_b32 v91, s101, v91
    s_waitcnt vmcnt(0)
    v_xor_b32 v92, s98, v92
    v_xor_b32 v93, s99, v93
    v_xor_b32 v94, s100, v94
    v_xor_b32 v95, s101, v95
    v_or_b32 v15, v64, v65
    v_or3_b32 v15, v15, v66, v67
    v_or3_b32 v15, v15, v68, v69
    v_or3_b32 v15, v15, v70, v71
    v_or3_b32 v15, v15, v72, v73
    v_or3_b32 v15, v15, v74, v75
    v_or3_b32 v15, v15, v76, v77
    v_or3_b32 v15, v15, v78, v79
    v_or3_b32 v15, v15, v80, v81
    v_or3_b32 v15, v15, v82, v83
    v_or3_b32 v15, v15, v84, v85
    v_or3_b32 v15, v15, v86, v87
    v_or3_b32 v15, v15, v88, v89
    v_or3_b32 v15, v15, v90, v91
    v_or3_b32 v15, v15, v92, v93
    v_or3_b32 v15, v15, v94, v95
    v_and_b32 v15, 0xff, v15
    v_cmp_ne_u32 vcc, 0, v15
    s_nop 0
    s_cmp_eq_u64 vcc, 0
    s_cbranch_scc1 Lpdone_103
    s_sub_u32 s60, s60, 1
    s_cbranch_scc1 Lpdone_103
    s_branch Lpoll_102
Lpdone_103:
    v_pk_add_f32 v[64:65], v[64:65], v[80:81]
    v_pk_add_f32 v[66:67], v[66:67], v[82:83]
    v_pk_add_f32 v[68:69], v[68:69], v[84:85]
    v_pk_add_f32 v[70:71], v[70:71], v[86:87]
    v_pk_add_f32 v[72:73], v[72:73], v[88:89]
    v_pk_add_f32 v[74:75], v[74:75], v[90:91]
    v_pk_add_f32 v[76:77], v[76:77], v[92:93]
    v_pk_add_f32 v[78:79], v[78:79], v[94:95]
    v_pk_add_f32 v[64:65], v[64:65], v[72:73]
    v_pk_add_f32 v[66:67], v[66:67], v[74:75]
    v_pk_add_f32 v[68:69], v[68:69], v[76:77]
    v_pk_add_f32 v[70:71], v[70:71], v[78:79]
    v_cvt_pk_bf16_f32 v72, v64, v65
    v_cvt_pk_bf16_f32 v73, v66, v67
    v_cvt_pk_bf16_f32 v74, v68, v69
    v_cvt_pk_bf16_f32 v75, v70, v71
    v_lshlrev_b32 v64, 16, v72
    v_and_b32 v65, 0xffff0000, v72
    v_lshlrev_b32 v66, 16, v73
    v_and_b32 v67, 0xffff0000, v73
    v_lshlrev_b32 v68, 16, v74
    v_and_b32 v69, 0xffff0000, v74
    v_lshlrev_b32 v70, 16, v75
    v_and_b32 v71, 0xffff0000, v75
    v_add_f32_dpp v76, v64, v18 row_ror:8 row_mask:0xf bank_mask:0xf
    v_add_f32_dpp v77, v65, v18 row_ror:8 row_mask:0xf bank_mask:0xf
    v_add_f32_dpp v78, v66, v18 row_ror:8 row_mask:0xf bank_mask:0xf
    v_add_f32_dpp v79, v67, v18 row_ror:8 row_mask:0xf bank_mask:0xf
    v_add_f32_dpp v80, v68, v18 row_ror:8 row_mask:0xf bank_mask:0xf
    v_add_f32_dpp v81, v69, v18 row_ror:8 row_mask:0xf bank_mask:0xf
    v_add_f32_dpp v82, v70, v18 row_ror:8 row_mask:0xf bank_mask:0xf
    v_add_f32_dpp v83, v71, v18 row_ror:8 row_mask:0xf bank_mask:0xf
    v_cvt_pk_bf16_f32 v72, v76, v77
    v_cvt_pk_bf16_f32 v73, v78, v79
    v_cvt_pk_bf16_f32 v74, v80, v81
    v_cvt_pk_bf16_f32 v75, v82, v83
    v_lshlrev_b32 v76, 16, v72
    v_and_b32 v77, 0xffff0000, v72
    v_lshlrev_b32 v78, 16, v73
    v_and_b32 v79, 0xffff0000, v73
    v_lshlrev_b32 v80, 16, v74
    v_and_b32 v81, 0xffff0000, v74
    v_lshlrev_b32 v82, 16, v75
    v_and_b32 v83, 0xffff0000, v75
    s_waitcnt lgkmcnt(0)
    v_mul_f32 v76, v28, v76
    v_mul_f32 v77, v29, v77
    v_mul_f32 v78, v30, v78
    v_mul_f32 v79, v31, v79
    v_mul_f32 v80, v32, v80
    v_mul_f32 v81, v33, v81
    v_mul_f32 v82, v34, v82
    v_mul_f32 v83, v35, v83
    v_cvt_pk_bf16_f32 v72, v76, v77
    v_cvt_pk_bf16_f32 v73, v78, v79
    v_cvt_pk_bf16_f32 v74, v80, v81
    v_cvt_pk_bf16_f32 v75, v82, v83
    v_lshlrev_b32 v76, 16, v72
    v_and_b32 v77, 0xffff0000, v72
    v_lshlrev_b32 v78, 16, v73
    v_and_b32 v79, 0xffff0000, v73
    v_lshlrev_b32 v80, 16, v74
    v_and_b32 v81, 0xffff0000, v74
    v_lshlrev_b32 v82, 16, v75
    v_and_b32 v83, 0xffff0000, v75
    v_add_f32 v76, v76, v64
    v_add_f32 v77, v77, v65
    v_add_f32 v78, v78, v66
    v_add_f32 v79, v79, v67
    v_add_f32 v80, v80, v68
    v_add_f32 v81, v81, v69
    v_add_f32 v82, v82, v70
    v_add_f32 v83, v83, v71
    v_cvt_pk_bf16_f32 v20, v76, v77
    v_cvt_pk_bf16_f32 v21, v78, v79
    v_cvt_pk_bf16_f32 v22, v80, v81
    v_cvt_pk_bf16_f32 v23, v82, v83
    v_mov_b32_dpp v20, v20 row_ror:8 row_mask:0xf bank_mask:0xc
    v_mov_b32_dpp v21, v21 row_ror:8 row_mask:0xf bank_mask:0xc
    v_mov_b32_dpp v22, v22 row_ror:8 row_mask:0xf bank_mask:0xc
    v_mov_b32_dpp v23, v23 row_ror:8 row_mask:0xf bank_mask:0xc
    v_mov_b32 v24, v20
    v_mov_b32 v25, v21
    v_mov_b32 v26, v22
    v_mov_b32 v27, v23
    v_mov_b32_dpp v24, v20 row_ror:4 row_mask:0xf bank_mask:0x5
    v_mov_b32_dpp v25, v21 row_ror:4 row_mask:0xf bank_mask:0x5
    v_mov_b32_dpp v26, v22 row_ror:4 row_mask:0xf bank_mask:0x5
    v_mov_b32_dpp v27, v23 row_ror:4 row_mask:0xf bank_mask:0x5
    v_mov_b32_dpp v20, v20 row_ror:4 row_mask:0xf bank_mask:0xa
    v_mov_b32_dpp v21, v21 row_ror:4 row_mask:0xf bank_mask:0xa
    v_mov_b32_dpp v22, v22 row_ror:4 row_mask:0xf bank_mask:0xa
    v_mov_b32_dpp v23, v23 row_ror:4 row_mask:0xf bank_mask:0xa
    s_nop 1
    v_mfma_f32_16x16x32_bf16 v[64:67], v[128:131], v[20:23], 0
    v_mfma_f32_16x16x32_bf16 v[68:71], v[136:139], v[20:23], 0
    v_mfma_f32_16x16x32_bf16 v[72:75], v[144:147], v[20:23], 0
    v_mfma_f32_16x16x32_bf16 v[76:79], v[152:155], v[20:23], 0
    v_mfma_f32_16x16x32_bf16 v[80:83], v[160:163], v[20:23], 0
    v_mfma_f32_16x16x32_bf16 v[84:87], v[168:171], v[20:23], 0
    v_mfma_f32_16x16x32_bf16 v[88:91], v[176:179], v[20:23], 0
    v_mfma_f32_16x16x32_bf16 v[92:95], v[184:187], v[20:23], 0
    v_mfma_f32_16x16x32_bf16 v[64:67], v[132:135], v[24:27], v[64:67]
    v_mfma_f32_16x16x32_bf16 v[68:71], v[140:143], v[24:27], v[68:71]
    v_mfma_f32_16x16x32_bf16 v[72:75], v[148:151], v[24:27], v[72:75]
    v_mfma_f32_16x16x32_bf16 v[76:79], v[156:159], v[24:27], v[76:79]
    v_mfma_f32_16x16x32_bf16 v[80:83], v[164:167], v[24:27], v[80:83]
    v_mfma_f32_16x16x32_bf16 v[84:87], v[172:175], v[24:27], v[84:87]
    v_mfma_f32_16x16x32_bf16 v[88:91], v[180:183], v[24:27], v[88:91]
    v_mfma_f32_16x16x32_bf16 v[92:95], v[188:191], v[24:27], v[92:95]
    s_nop 1
    v_mov_b32_dpp v64, v68 quad_perm:[0,1,2,3] row_mask:0xf bank_mask:0x2
    v_mov_b32_dpp v65, v69 quad_perm:[0,1,2,3] row_mask:0xf bank_mask:0x2
    v_mov_b32_dpp v66, v70 quad_perm:[0,1,2,3] row_mask:0xf bank_mask:0x2
    v_mov_b32_dpp v67, v71 quad_perm:[0,1,2,3] row_mask:0xf bank_mask:0x2
    v_mov_b32_dpp v64, v72 quad_perm:[0,1,2,3] row_mask:0xf bank_mask:0x4
    v_mov_b32_dpp v65, v73 quad_perm:[0,1,2,3] row_mask:0xf bank_mask:0x4
    v_mov_b32_dpp v66, v74 quad_perm:[0,1,2,3] row_mask:0xf bank_mask:0x4
    v_mov_b32_dpp v67, v75 quad_perm:[0,1,2,3] row_mask:0xf bank_mask:0x4
    v_mov_b32_dpp v64, v76 quad_perm:[0,1,2,3] row_mask:0xf bank_mask:0x8
    v_mov_b32_dpp v65, v77 quad_perm:[0,1,2,3] row_mask:0xf bank_mask:0x8
    v_mov_b32_dpp v66, v78 quad_perm:[0,1,2,3] row_mask:0xf bank_mask:0x8
    v_mov_b32_dpp v67, v79 quad_perm:[0,1,2,3] row_mask:0xf bank_mask:0x8
    v_add_u32 v64, 0x80, v64
    v_add_u32 v65, 0x80, v65
    v_add_u32 v66, 0x80, v66
    v_add_u32 v67, 0x80, v67
    v_bfi_b32 v64, v3, s98, v64
    v_bfi_b32 v65, v3, s99, v65
    v_bfi_b32 v66, v3, s100, v66
    v_bfi_b32 v67, v3, s101, v67
    global_store_dwordx4 v16, v[64:67], s[42:43] offset:0 sc1
    v_mov_b32_dpp v80, v84 quad_perm:[0,1,2,3] row_mask:0xf bank_mask:0x2
    v_mov_b32_dpp v81, v85 quad_perm:[0,1,2,3] row_mask:0xf bank_mask:0x2
    v_mov_b32_dpp v82, v86 quad_perm:[0,1,2,3] row_mask:0xf bank_mask:0x2
    v_mov_b32_dpp v83, v87 quad_perm:[0,1,2,3] row_mask:0xf bank_mask:0x2
    v_mov_b32_dpp v80, v88 quad_perm:[0,1,2,3] row_mask:0xf bank_mask:0x4
    v_mov_b32_dpp v81, v89 quad_perm:[0,1,2,3] row_mask:0xf bank_mask:0x4
    v_mov_b32_dpp v82, v90 quad_perm:[0,1,2,3] row_mask:0xf bank_mask:0x4
    v_mov_b32_dpp v83, v91 quad_perm:[0,1,2,3] row_mask:0xf bank_mask:0x4
    v_mov_b32_dpp v80, v92 quad_perm:[0,1,2,3] row_mask:0xf bank_mask:0x8
    v_mov_b32_dpp v81, v93 quad_perm:[0,1,2,3] row_mask:0xf bank_mask:0x8
    v_mov_b32_dpp v82, v94 quad_perm:[0,1,2,3] row_mask:0xf bank_mask:0x8
    v_mov_b32_dpp v83, v95 quad_perm:[0,1,2,3] row_mask:0xf bank_mask:0x8
    v_add_u32 v80, 0x80, v80
    v_add_u32 v81, 0x80, v81
    v_add_u32 v82, 0x80, v82
    v_add_u32 v83, 0x80, v83
    v_bfi_b32 v80, v3, s98, v80
    v_bfi_b32 v81, v3, s99, v81
    v_bfi_b32 v82, v3, s100, v82
    v_bfi_b32 v83, v3, s101, v83
    global_store_dwordx4 v16, v[80:83], s[42:43] offset:256 sc1
    v_mov_b32 v12, 0
Llw_104:
    ds_read_b32 v13, v12 offset:60
    s_waitcnt lgkmcnt(0)
    v_readfirstlane_b32 s4, v13
    s_nop 0
    s_cmp_ge_u32 s4, 2
    s_cbranch_scc1 Llwd_105
    s_sleep 2
    s_branch Llw_104
Llwd_105:
    s_mov_b32 s60, 1048576
Lpoll_106:
    global_load_dwordx4 v[96:99], v17, s[42:43] offset:0 sc1
    global_load_dwordx4 v[100:103], v17, s[42:43] offset:1024 sc1
    global_load_dwordx4 v[104:107], v17, s[42:43] offset:2048 sc1
    global_load_dwordx4 v[108:111], v17, s[42:43] offset:3072 sc1
    s_waitcnt vmcnt(3)
    v_xor_b32 v96, s98, v96
    v_xor_b32 v97, s99, v97
    v_xor_b32 v98, s100, v98
    v_xor_b32 v99, s101, v99
    s_waitcnt vmcnt(2)
    v_xor_b32 v100, s98, v100
    v_xor_b32 v101, s99, v101
    v_xor_b32 v102, s100, v102
    v_xor_b32 v103, s101, v103
    s_waitcnt vmcnt(1)
    v_xor_b32 v104, s98, v104
    v_xor_b32 v105, s99, v105
    v_xor_b32 v106, s100, v106
    v_xor_b32 v107, s101, v107
    s_waitcnt vmcnt(0)
    v_xor_b32 v108, s98, v108
    v_xor_b32 v109, s99, v109
    v_xor_b32 v110, s100, v110
    v_xor_b32 v111, s101, v111
    v_or_b32 v15, v96, v97
    v_or3_b32 v15, v15, v98, v99
    v_or3_b32 v15, v15, v100, v101
    v_or3_b32 v15, v15, v102, v103
    v_or3_b32 v15, v15, v104, v105
    v_or3_b32 v15, v15, v106, v107
    v_or3_b32 v15, v15, v108, v109
    v_or3_b32 v15, v15, v110, v111
    v_and_b32 v15, 0xff, v15
    v_cmp_ne_u32 vcc, 0, v15
    s_nop 0
    s_cmp_eq_u64 vcc, 0
    s_cbranch_scc1 Lpdone_107
    s_sub_u32 s60, s60, 1
    s_cbranch_scc1 Lpdone_107
    s_branch Lpoll_106
Lpdone_107:
    v_pk_add_f32 v[96:97], v[96:97], v[104:105]
    v_pk_add_f32 v[98:99], v[98:99], v[106:107]
    v_pk_add_f32 v[100:101], v[100:101], v[108:109]
    v_pk_add_f32 v[102:103], v[102:103], v[110:111]
    v_pk_add_f32 v[96:97], v[96:97], v[100:101]
    v_pk_add_f32 v[98:99], v[98:99], v[102:103]
    v_mov_b32 v100, v96
    v_mov_b32 v101, v97
    v_mov_b32 v102, v98
    v_mov_b32 v103, v99
    v_permlane32_swap_b32 v96, v100
    v_permlane32_swap_b32 v97, v101
    v_permlane32_swap_b32 v98, v102
    v_permlane32_swap_b32 v99, v103
    v_pk_add_f32 v[96:97], v[96:97], v[100:101]
    v_pk_add_f32 v[98:99], v[98:99], v[102:103]
    v_cvt_pk_bf16_f32 v100, v96, v97
    v_cvt_pk_bf16_f32 v101, v98, v99
    v_and_b32 v12, 31, v0
    v_lshlrev_b32 v12, 3, v12
    ds_write_b64 v12, v[100:101] offset:256
    v_mov_b32 v12, 0
    v_mov_b32 v13, 1
    ds_write_b32 v12, v13 offset:8
L_noq:
    v_mov_b32 v12, 0
Llw_108:
    ds_read_b32 v13, v12 offset:20
    s_waitcnt lgkmcnt(0)
    v_readfirstlane_b32 s4, v13
    s_nop 0
    s_cmp_ge_u32 s4, 4
    s_cbranch_scc1 Llwd_109
    s_sleep 4
    s_branch Llw_108
Llwd_109:
    s_cmp_eq_u32 s61, 2
    s_cbranch_scc1 L_w6
    s_cmp_lg_u32 s61, 1
    s_cbranch_scc1 L_bg
    s_cmp_lg_u32 s58, 0
    s_cbranch_scc1 L_now
    s_lshl_b32 s4, s59, 7
    s_add_u32 s4, s4, 16384
    v_mov_b32 v12, s4
    v_mov_b32 v13, 0
    s_mov_b64 exec, 1
    global_store_dword v12, v13, s[42:43] sc1
L_now:
    s_cmp_ge_u32 s2, 16
    s_cbranch_scc1 L_bg
    s_lshl_b32 s4, s2, 8
    s_add_u32 s4, s4, 0x1000
    s_mov_b64 exec, 15
    v_lshl_add_u32 v12, v0, 2, s4
    v_mov_b32 v13, 0
    global_store_dword v12, v13, s[42:43] sc1
    s_branch L_bg
L_w6:
    s_cmp_ge_u32 s2, 224
    s_cbranch_scc1 L_w6d
    s_cmp_ge_u32 s2, 64
    s_cbranch_scc1 L_bg
    s_lshl_b32 s4, s2, 9
    s_add_u32 s4, s4, 65536
    v_lshl_add_u32 v12, v0, 3, s4
    v_mov_b32 v14, -1
    v_mov_b32 v15, -1
    global_store_dwordx2 v12, v[14:15], s[42:43] sc1
    v_and_b32 v12, 7, v0
    v_lshlrev_b32 v12, 4, v12
    s_lshl_b32 s4, s2, 7
    v_add_u32 v13, s4, v12
    v_lshrrev_b32 v16, 1, v13
    global_load_dwordx2 v[36:37], v16, s[16:17]
    v_bfe_u32 v14, v0, 3, 2
    v_lshl_add_u32 v14, v14, 13, v13
    v_add_u32 v14, 196608, v14
    v_lshrrev_b32 v17, 5, v0
    v_lshl_add_u32 v16, v17, 15, v14
    v_add_u32 v16, 32768, v16
    s_mov_b32 s60, 1048576
Lpoll_110:
    global_load_dwordx4 v[20:23], v16, s[42:43] offset:0 sc1
    global_load_dwordx4 v[24:27], v14, s[42:43] offset:0 sc1
    s_waitcnt vmcnt(1)
    v_xor_b32 v20, s98, v20
    v_xor_b32 v21, s99, v21
    v_xor_b32 v22, s100, v22
    v_xor_b32 v23, s101, v23
    s_waitcnt vmcnt(0)
    v_xor_b32 v24, s98, v24
    v_xor_b32 v25, s99, v25
    v_xor_b32 v26, s100, v26
    v_xor_b32 v27, s101, v27
    v_or_b32 v15, v20, v21
    v_or3_b32 v15, v15, v22, v23
    v_or3_b32 v15, v15, v24, v25
    v_or3_b32 v15, v15, v26, v27
    v_and_b32 v15, 0xff, v15
    v_cmp_ne_u32 vcc, 0, v15
    s_nop 0
    s_cmp_eq_u64 vcc, 0
    s_cbranch_scc1 Lpdone_111
    s_sub_u32 s60, s60, 1
    s_cbranch_scc1 Lpdone_111
    s_sleep 8
    s_branch Lpoll_110
Lpdone_111:
    v_add_f32_dpp v20, v20, v20 row_ror:8 row_mask:0xf bank_mask:0xf
    v_add_f32_dpp v21, v21, v21 row_ror:8 row_mask:0xf bank_mask:0xf
    v_add_f32_dpp v22, v22, v22 row_ror:8 row_mask:0xf bank_mask:0xf
    v_add_f32_dpp v23, v23, v23 row_ror:8 row_mask:0xf bank_mask:0xf
    v_add_f32_dpp v24, v24, v24 row_ror:8 row_mask:0xf bank_mask:0xf
    v_add_f32_dpp v25, v25, v25 row_ror:8 row_mask:0xf bank_mask:0xf
    v_add_f32_dpp v26, v26, v26 row_ror:8 row_mask:0xf bank_mask:0xf
    v_add_f32_dpp v27, v27, v27 row_ror:8 row_mask:0xf bank_mask:0xf
    v_mov_b32 v28, v20
    v_mov_b32 v29, v21
    v_mov_b32 v30, v22
    v_mov_b32 v31, v23
    v_mov_b32 v32, v24
    v_mov_b32 v33, v25
    v_mov_b32 v34, v26
    v_mov_b32 v35, v27
    v_permlane16_swap_b32 v20, v28
    v_permlane16_swap_b32 v21, v29
    v_permlane16_swap_b32 v22, v30
    v_permlane16_swap_b32 v23, v31
    v_permlane16_swap_b32 v24, v32
    v_permlane16_swap_b32 v25, v33
    v_permlane16_swap_b32 v26, v34
    v_permlane16_swap_b32 v27, v35
    v_add_f32 v20, v20, v28
    v_add_f32 v21, v21, v29
    v_add_f32 v22, v22, v30
    v_add_f32 v23, v23, v31
    v_add_f32 v24, v24, v32
    v_add_f32 v25, v25, v33
    v_add_f32 v26, v26, v34
    v_add_f32 v27, v27, v35
    v_cvt_pk_bf16_f32 v28, v20, v21
    v_cvt_pk_bf16_f32 v29, v22, v23
    v_cvt_pk_bf16_f32 v30, v24, v25
    v_cvt_pk_bf16_f32 v31, v26, v27
    v_lshlrev_b32 v20, 16, v28
    v_and_b32 v21, 0xffff0000, v28
    v_lshlrev_b32 v22, 16, v29
    v_and_b32 v23, 0xffff0000, v29
    v_lshlrev_b32 v24, 16, v30
    v_and_b32 v25, 0xffff0000, v30
    v_lshlrev_b32 v26, 16, v31
    v_and_b32 v27, 0xffff0000, v31
    v_cvt_f32_u32 v18, v17
    v_add_f32 v20, v18, v20
    v_add_f32 v21, v18, v21
    v_add_f32 v22, v18, v22
    v_add_f32 v23, v18, v23
    v_cvt_pk_bf16_f32 v28, v20, v21
    v_cvt_pk_bf16_f32 v29, v22, v23
    v_lshlrev_b32 v20, 16, v28
    v_and_b32 v21, 0xffff0000, v28
    v_lshlrev_b32 v22, 16, v29
    v_and_b32 v23, 0xffff0000, v29
    v_lshlrev_b32 v32, 16, v36
    v_and_b32 v33, 0xffff0000, v36
    v_lshlrev_b32 v34, 16, v37
    v_and_b32 v35, 0xffff0000, v37
    ds_write_b128 v12, v[24:27] offset:512
    ds_write_b128 v12, v[32:35] offset:640
    v_or_b32 v20, s98, v20
    v_or_b32 v21, s99, v21
    v_or_b32 v22, s100, v22
    v_or_b32 v23, s101, v23
    v_lshl_add_u32 v13, v17, 13, v13
    v_add_u32 v13, 32768, v13
    s_mov_b32 exec_lo, 0xff
    s_mov_b32 exec_hi, 0xff
    global_store_dwordx4 v13, v[20:23], s[42:43] sc1
    s_branch L_bg
L_w6d:
    s_lshl_b32 s5, s68, 2
    s_add_u32 s5, s5, s69
    s_sub_u32 s5, s5, 28
    s_lshl_b32 s5, s5, 6
    s_add_u32 s5, s5, 294912
    v_lshl_add_u32 v14, v1, 11, s5
    v_lshl_add_u32 v14, v2, 4, v14
    s_mov_b32 s60, 1048576
Lpoll_112:
    global_load_dwordx4 v[20:23], v14, s[42:43] offset:0 sc1
    s_waitcnt vmcnt(0)
    v_xor_b32 v20, s98, v20
    v_xor_b32 v21, s99, v21
    v_xor_b32 v22, s100, v22
    v_xor_b32 v23, s101, v23
    v_or_b32 v15, v20, v21
    v_or3_b32 v15, v15, v22, v23
    v_and_b32 v15, 0xff, v15
    v_cmp_ne_u32 vcc, 0, v15
    s_nop 0
    s_cmp_eq_u64 vcc, 0
    s_cbranch_scc1 Lpdone_113
    s_sub_u32 s60, s60, 1
    s_cbranch_scc1 Lpdone_113
    s_sleep 8
    s_branch Lpoll_112
Lpdone_113:
    v_add_f32_dpp v20, v20, v20 row_ror:8 row_mask:0xf bank_mask:0xf
    v_add_f32_dpp v21, v21, v21 row_ror:8 row_mask:0xf bank_mask:0xf
    v_add_f32_dpp v22, v22, v22 row_ror:8 row_mask:0xf bank_mask:0xf
    v_add_f32_dpp v23, v23, v23 row_ror:8 row_mask:0xf bank_mask:0xf
    v_add_f32_dpp v20, v20, v20 row_ror:4 row_mask:0xf bank_mask:0xf
    v_add_f32_dpp v21, v21, v21 row_ror:4 row_mask:0xf bank_mask:0xf
    v_add_f32_dpp v22, v22, v22 row_ror:4 row_mask:0xf bank_mask:0xf
    v_add_f32_dpp v23, v23, v23 row_ror:4 row_mask:0xf bank_mask:0xf
    v_cvt_pk_bf16_f32 v28, v20, v21
    v_cvt_pk_bf16_f32 v29, v22, v23
    v_lshlrev_b32 v20, 16, v28
    v_and_b32 v21, 0xffff0000, v28
    v_lshlrev_b32 v22, 16, v29
    v_and_b32 v23, 0xffff0000, v29
    v_and_b32 v12, 3, v0
    v_lshlrev_b32 v12, 4, v12
    v_lshl_add_u32 v12, v2, 6, v12
    ds_write_b128 v12, v[20:23] offset:512
L_bg:
    s_mov_b64 exec, -1
    s_lshl_b32 s4, s57, 17
    s_add_u32 s44, s24, s4
    s_addc_u32 s45, s25, 0
    s_mov_b32 s46, 0x20000
    s_mov_b32 s47, 0x20000
    v_lshrrev_b32 v18, 5, v0
    v_lshlrev_b32 v18, 16, v18
    v_and_b32 v19, 31, v0
    v_lshl_add_u32 v18, v19, 4, v18
    s_xor_b32 s13, s57, 0
    s_and_b32 s13, s13, 1
    s_lshl_b32 s13, s13, 9
    s_lshl_b32 s11, s57, 1
    s_xor_b32 s11, s11, s61
    s_lshl_b32 s4, s56, 1
    s_or_b32 s4, s4, s58
    s_lshl_b32 s4, s4, 2
    s_and_b32 s4, s4, 63
    s_xor_b32 s11, s11, s4
    s_mov_b32 s12, 0
Lbg_114:
    s_xor_b32 s5, s12, s11
    s_lshl_b32 s6, s5, 10
    s_add_u32 m0, s6, 86016
    s_add_u32 s6, s6, s13
    s_and_b32 s7, s5, 3
    s_lshl_b32 s7, s7, 5
    s_and_b32 s5, s5, 8
    s_lshl_b32 s5, s5, 4
    s_or_b32 s5, s5, s7
    v_xor_b32 v19, s5, v18
    buffer_load_dwordx4 v19, s[44:47], s6 offen  lds
    s_add_u32 s12, s12, 4
    s_waitcnt vmcnt(0)
    s_cmp_lt_u32 s12, 64
    s_cbranch_scc1 Lbg_114
    s_mov_b64 exec, 1
    v_mov_b32 v12, 0
    v_mov_b32 v13, 1
    s_waitcnt lgkmcnt(0)
    ds_add_u32 v12, v13 offset:56
    s_mov_b64 exec, -1
    v_mov_b32 v12, 0
Llw_115:
    ds_read_b32 v13, v12 offset:56
    s_waitcnt lgkmcnt(0)
    v_readfirstlane_b32 s4, v13
    s_nop 0
    s_cmp_ge_u32 s4, 4
    s_cbranch_scc1 Llwd_116
    s_sleep 4
    s_branch Llw_115
Llwd_116:
    v_lshrrev_b32 v236, 4, v0
    v_bfe_u32 v237, v0, 2, 2
    v_lshlrev_b32 v238, 13, v236
    v_lshl_add_u32 v238, v237, 10, v238
    v_and_b32 v239, 3, v0
    v_lshl_add_u32 v238, v239, 3, v238
    v_bfe_u32 v237, v0, 2, 3
    s_and_b32 s4, s61, 1
    s_lshl_b32 s4, s4, 2
    v_xor_b32 v237, s4, v237
    s_lshr_b32 s4, s61, 1
    s_lshl_b32 s4, s4, 8
    s_add_u32 s4, s4, 86016
    v_add_u32 v238, s4, v238
    v_xor_b32 v232, 0, v237
    v_lshl_add_u32 v232, v232, 5, v238
    v_xor_b32 v233, 1, v237
    v_lshl_add_u32 v233, v233, 5, v238
    v_xor_b32 v234, 2, v237
    v_lshl_add_u32 v234, v234, 5, v238
    v_xor_b32 v235, 3, v237
    v_lshl_add_u32 v235, v235, 5, v238
    v_lshlrev_b32 v226, 8, v239
    v_lshl_add_u32 v226, v236, 4, v226
    s_xor_b32 s4, s57, 0
    s_and_b32 s4, s4, 1
    s_lshl_b32 s4, s4, 2
    s_xor_b32 s4, s4, s3
    s_xor_b32 s4, s4, 4
    s_lshl_b32 s4, s4, 1
    s_lshl_b32 s5, s56, 4
    s_add_u32 s4, s4, s5
    s_lshl_b32 s4, s4, 13
    s_and_b32 s5, s2, 63
    s_lshl_b32 s5, s5, 7
    s_add_u32 s4, s4, s5
    s_add_u32 s4, s4, 524288
    v_lshrrev_b32 v227, 5, v0
    v_lshl_add_u32 v227, v227, 13, s4
    v_and_b32 v228, 31, v0
    v_lshl_add_u32 v227, v228, 2, v227
    v_lshlrev_b32 v228, 3, v239
    v_lshrrev_b32 v228, v228, s14
    v_mov_b32 v229, 0xff
    ds_read_b64_tr_b16 v[128:129], v232 offset:0
    ds_read_b64_tr_b16 v[130:131], v232 offset:4096
    ds_read_b64_tr_b16 v[132:133], v232 offset:32768
    ds_read_b64_tr_b16 v[134:135], v232 offset:36864
    ds_read_b64_tr_b16 v[136:137], v232 offset:512
    ds_read_b64_tr_b16 v[138:139], v232 offset:4608
    ds_read_b64_tr_b16 v[140:141], v232 offset:33280
    ds_read_b64_tr_b16 v[142:143], v232 offset:37376
    s_waitcnt lgkmcnt(0)
    ds_read_b64_tr_b16 v[144:145], v233 offset:0
    ds_read_b64_tr_b16 v[146:147], v233 offset:4096
    ds_read_b64_tr_b16 v[148:149], v233 offset:32768
    ds_read_b64_tr_b16 v[150:151], v233 offset:36864
    ds_read_b64_tr_b16 v[152:153], v233 offset:512
    ds_read_b64_tr_b16 v[154:155], v233 offset:4608
    ds_read_b64_tr_b16 v[156:157], v233 offset:33280
    ds_read_b64_tr_b16 v[158:159], v233 offset:37376
    s_waitcnt lgkmcnt(0)
    ds_read_b64_tr_b16 v[160:161], v234 offset:0
    ds_read_b64_tr_b16 v[162:163], v234 offset:4096
    ds_read_b64_tr_b16 v[164:165], v234 offset:32768
    ds_read_b64_tr_b16 v[166:167], v234 offset:36864
    ds_read_b64_tr_b16 v[168:169], v234 offset:512
    ds_read_b64_tr_b16 v[170:171], v234 offset:4608
    ds_read_b64_tr_b16 v[172:173], v234 offset:33280
    ds_read_b64_tr_b16 v[174:175], v234 offset:37376
    s_waitcnt lgkmcnt(0)
    ds_read_b64_tr_b16 v[176:177], v235 offset:0
    ds_read_b64_tr_b16 v[178:179], v235 offset:4096
    ds_read_b64_tr_b16 v[180:181], v235 offset:32768
    ds_read_b64_tr_b16 v[182:183], v235 offset:36864
    ds_read_b64_tr_b16 v[184:185], v235 offset:512
    ds_read_b64_tr_b16 v[186:187], v235 offset:4608
    ds_read_b64_tr_b16 v[188:189], v235 offset:33280
    ds_read_b64_tr_b16 v[190:191], v235 offset:37376
    s_waitcnt lgkmcnt(0)
    s_mov_b64 exec, 1
    v_mov_b32 v12, 0
    v_mov_b32 v13, 1
    s_waitcnt lgkmcnt(0)
    ds_add_u32 v12, v13 offset:56
    s_mov_b64 exec, -1
    v_mov_b32 v12, 0
Llw_117:
    ds_read_b32 v13, v12 offset:56
    s_waitcnt lgkmcnt(0)
    v_readfirstlane_b32 s4, v13
    s_nop 0
    s_cmp_ge_u32 s4, 8
    s_cbranch_scc1 Llwd_118
    s_sleep 2
    s_branch Llw_117
Llwd_118:
    s_xor_b32 s13, s13, 512
    s_mov_b32 s12, 0
Lbg_119:
    s_xor_b32 s5, s12, s11
    s_lshl_b32 s6, s5, 10
    s_add_u32 m0, s6, 86016
    s_add_u32 s6, s6, s13
    s_and_b32 s7, s5, 3
    s_lshl_b32 s7, s7, 5
    s_and_b32 s5, s5, 8
    s_lshl_b32 s5, s5, 4
    s_or_b32 s5, s5, s7
    v_xor_b32 v19, s5, v18
    buffer_load_dwordx4 v19, s[44:47], s6 offen  lds
    s_add_u32 s12, s12, 4
    s_waitcnt vmcnt(0)
    s_cmp_lt_u32 s12, 64
    s_cbranch_scc1 Lbg_119
    s_mov_b64 exec, 1
    v_mov_b32 v12, 0
    v_mov_b32 v13, 1
    s_waitcnt lgkmcnt(0)
    ds_add_u32 v12, v13 offset:56
    s_mov_b64 exec, -1
    s_cmp_lg_u32 s61, 3
    s_cbranch_scc1 L_notlb
    v_mul_u32_u24 v12, 65536, v0
    s_mov_b64 exec, 0xfffffff
    global_load_dword v20, v12, s[32:33]
    global_load_dword v21, v12, s[28:29]
    global_load_dword v22, v12, s[30:31]
    s_waitcnt vmcnt(0)
    s_mov_b64 exec, -1
L_notlb:
    s_cmp_ge_u32 s26, 176
    s_cbranch_scc1 L_nomf
    s_cmp_lt_u32 s2, 64
    s_cbranch_scc1 L_nomf
    s_lshl_b32 s4, s61, 11
    s_add_u32 s4, s4, 32768
    v_lshl_add_u32 v12, v0, 4, s4
    v_add_u32 v13, 8192, v12
    s_mov_b32 s60, 1048576
    global_load_dwordx4 v[104:107], v12, s[42:43] offset:0
    global_load_dwordx4 v[108:111], v12, s[42:43] offset:1024
    global_load_dwordx4 v[112:115], v13, s[42:43] offset:0
    global_load_dwordx4 v[116:119], v13, s[42:43] offset:1024
    s_branch Lpchk_122
Lpoll_120:
    global_load_dwordx4 v[104:107], v12, s[42:43] offset:0 sc1
    global_load_dwordx4 v[108:111], v12, s[42:43] offset:1024 sc1
    global_load_dwordx4 v[112:115], v13, s[42:43] offset:0 sc1
    global_load_dwordx4 v[116:119], v13, s[42:43] offset:1024 sc1
Lpchk_122:
    s_waitcnt vmcnt(3)
    v_xor_b32 v104, s98, v104
    v_xor_b32 v105, s99, v105
    v_xor_b32 v106, s100, v106
    v_xor_b32 v107, s101, v107
    s_waitcnt vmcnt(2)
    v_xor_b32 v108, s98, v108
    v_xor_b32 v109, s99, v109
    v_xor_b32 v110, s100, v110
    v_xor_b32 v111, s101, v111
    s_waitcnt vmcnt(1)
    v_xor_b32 v112, s98, v112
    v_xor_b32 v113, s99, v113
    v_xor_b32 v114, s100, v114
    v_xor_b32 v115, s101, v115
    s_waitcnt vmcnt(0)
    v_xor_b32 v116, s98, v116
    v_xor_b32 v117, s99, v117
    v_xor_b32 v118, s100, v118
    v_xor_b32 v119, s101, v119
    v_or_b32 v15, v104, v105
    v_or3_b32 v15, v15, v106, v107
    v_or3_b32 v15, v15, v108, v109
    v_or3_b32 v15, v15, v110, v111
    v_or3_b32 v15, v15, v112, v113
    v_or3_b32 v15, v15, v114, v115
    v_or3_b32 v15, v15, v116, v117
    v_or3_b32 v15, v15, v118, v119
    v_and_b32 v15, 0xff, v15
    v_cmp_ne_u32 vcc, 0, v15
    s_nop 0
    s_cmp_eq_u64 vcc, 0
    s_cbranch_scc1 Lpdone_121
    s_sub_u32 s60, s60, 1
    s_cbranch_scc1 Lpdone_121
    s_sleep 8
    s_branch Lpoll_120
Lpdone_121:
L_nomf:
    s_cmp_lt_u32 s2, 224
    s_cbranch_scc1 L_nomf2
    s_cmp_lg_u32 s61, 2
    s_cbranch_scc1 L_nomf2
    v_lshlrev_b32 v12, 7, v0
    v_add_u32 v12, 32768, v12
    s_mov_b32 s60, 1048576
    global_load_dwordx4 v[104:107], v12, s[42:43] offset:0
    s_branch Lpchk_125
Lpoll_123:
    global_load_dwordx4 v[104:107], v12, s[42:43] offset:0 sc1
Lpchk_125:
    s_waitcnt vmcnt(0)
    v_xor_b32 v104, s98, v104
    v_xor_b32 v105, s99, v105
    v_xor_b32 v106, s100, v106
    v_xor_b32 v107, s101, v107
    v_or_b32 v15, v104, v105
    v_or3_b32 v15, v15, v106, v107
    v_and_b32 v15, 0xff, v15
    v_cmp_ne_u32 vcc, 0, v15
    s_nop 0
    s_cmp_eq_u64 vcc, 0
    s_cbranch_scc1 Lpdone_124
    s_sub_u32 s60, s60, 1
    s_cbranch_scc1 Lpdone_124
    s_sleep 8
    s_branch Lpoll_123
Lpdone_124:
L_nomf2:
    s_cmp_lg_u32 s61, 1
    s_cbranch_scc1 L_noclaim
    v_mov_b32 v12, 0
Llw_126:
    ds_read_b32 v13, v12 offset:12
    s_waitcnt lgkmcnt(0)
    v_readfirstlane_b32 s4, v13
    s_nop 0
    s_cmp_ge_u32 s4, 4
    s_cbranch_scc1 Llwd_127
    s_sleep 8
    s_branch Llw_126
Llwd_127:
    s_mov_b32 s6, 3840
    s_cmp_eq_u32 s58, 0
    s_cselect_b32 s4, s6, 4096
    s_cselect_b32 s5, 4096, s6
    s_sub_u32 s7, s5, s4
    s_add_u32 s4, s4, 53248
    v_add_u32 v13, 0, v0
    v_mul_u32_u24 v14, 4096, v13
    v_lshrrev_b32 v14, 16, v14
    v_mul_u32_u24 v14, 7936, v14
    v_lshl_add_u32 v14, v13, 4, v14
    v_add_u32 v40, s4, v14
    ds_read_b128 v[28:31], v40
    v_lshlrev_b32 v21, 3, v0
    ds_read_b64 v[96:97], v21 offset:12288
    ds_read_b64 v[98:99], v21 offset:12800
    ds_read_b64 v[100:101], v21 offset:13312
    ds_read_b64 v[102:103], v21 offset:13824
    s_lshl_b32 s4, s15, 12
    s_add_u32 s4, s4, 2097152
    v_lshl_add_u32 v16, v0, 4, s4
    v_xor_b32 v17, 0x1000, v16
    s_lshl_b32 s4, s15, 7
    s_add_u32 s4, s4, 327680
    v_and_b32 v18, 7, v0
    v_lshl_add_u32 v18, v18, 4, s4
    v_xor_b32 v19, 0x80, v18
    s_mov_b32 s4, 0x07060302
    s_waitcnt lgkmcnt(0)
    v_add_u32 v40, s7, v40
    v_perm_b32 v36, v29, v28, s4
    v_perm_b32 v37, v31, v30, s4
    v_mov_b32 v38, v36
    v_mov_b32 v39, v37
    s_nop 0
    v_permlane32_swap_b32 v36, v38
    v_permlane32_swap_b32 v37, v39
    s_mov_b32 exec_lo, 0xffffffff
    s_mov_b32 exec_hi, 0x0
    global_store_dwordx4 v16, v[36:39], s[42:43] offset:0 sc1
    s_mov_b64 exec, -1
    v_max3_f32 v32, v96, v98, v100
    v_max_f32 v32, v32, v102
    s_nop 1
    v_max_f32_dpp v32, v32, v32 row_ror:8 row_mask:0xf bank_mask:0xf
    s_nop 1
    v_max_f32_dpp v32, v32, v32 row_ror:4 row_mask:0xf bank_mask:0xf
    s_nop 1
    v_max_f32_dpp v32, v32, v32 row_ror:2 row_mask:0xf bank_mask:0xf
    s_nop 1
    v_max_f32_dpp v32, v32, v32 row_ror:1 row_mask:0xf bank_mask:0xf
    v_mov_b32 v20, v32
    s_nop 1
    v_permlane16_swap_b32 v32, v20
    v_max_f32 v32, v32, v20
    v_mov_b32 v20, v32
    s_nop 1
    v_permlane32_swap_b32 v32, v20
    v_max_f32 v32, v32, v20
    v_sub_f32 v96, v96, v32
    v_mul_f32 v96, 0x3fb8aa3b, v96
    v_exp_f32 v96, v96
    v_sub_f32 v98, v98, v32
    v_mul_f32 v98, 0x3fb8aa3b, v98
    v_exp_f32 v98, v98
    v_sub_f32 v100, v100, v32
    v_mul_f32 v100, 0x3fb8aa3b, v100
    v_exp_f32 v100, v100
    v_sub_f32 v102, v102, v32
    v_mul_f32 v102, 0x3fb8aa3b, v102
    v_exp_f32 v102, v102
    v_mul_f32 v33, v96, v97
    v_fmac_f32 v33, v98, v99
    v_fmac_f32 v33, v100, v101
    v_fmac_f32 v33, v102, v103
    s_nop 1
    v_add_f32_dpp v33, v33, v33 row_ror:8 row_mask:0xf bank_mask:0xf
    s_nop 1
    v_add_f32_dpp v33, v33, v33 row_ror:4 row_mask:0xf bank_mask:0xf
    s_nop 1
    v_add_f32_dpp v33, v33, v33 row_ror:2 row_mask:0xf bank_mask:0xf
    s_nop 1
    v_add_f32_dpp v33, v33, v33 row_ror:1 row_mask:0xf bank_mask:0xf
    v_mov_b32 v20, v33
    s_nop 1
    v_permlane16_swap_b32 v33, v20
    v_add_f32 v33, v33, v20
    v_mov_b32 v20, v33
    s_nop 1
    v_permlane32_swap_b32 v33, v20
    v_add_f32 v33, v33, v20
    v_mov_b32 v34, v32
    v_mov_b32 v35, v33
    v_bfi_b32 v32, v3, s98, v32
    v_bfi_b32 v33, v3, s99, v33
    v_bfi_b32 v34, v3, s100, v34
    v_bfi_b32 v35, v3, s101, v35
    s_waitcnt vmcnt(0)
    s_mov_b64 exec, 0xff
    global_store_dwordx4 v18, v[32:35], s[42:43] sc1
    s_mov_b64 exec, -1
    v_and_b32 v24, 0xffffff00, v32
    v_and_b32 v25, 0xffffff00, v33
    v_mov_b32 v12, 0
Llw_128:
    ds_read_b32 v13, v12 offset:32
    s_waitcnt lgkmcnt(0)
    v_readfirstlane_b32 s4, v13
    s_nop 0
    s_cmp_ge_u32 s4, 43
    s_cbranch_scc1 Llwd_129
    s_sleep 8
    s_branch Llw_128
Llwd_129:
    s_and_b32 s4, s69, 15
    s_mul_i32 s4, s4, 256
    s_add_u32 s4, s4, 0x1000
    s_add_u32 s48, s42, s4
    s_addc_u32 s49, s43, 0
    s_mov_b32 s4, 16
    s_atomic_add s4, s[48:49], 0 glc
    s_mov_b32 s9, 0
    s_waitcnt lgkmcnt(0)
    s_add_u32 s4, s4, 8
    s_cmp_ge_u32 s4, 128
    s_cselect_b32 s9, 1140850688, s9
    s_cmp_ge_u32 s4, 165
    s_cselect_b32 s9, 1207959552, s9
    s_cmp_ge_u32 s4, 195
    s_cselect_b32 s9, 1275068416, s9
    s_cmp_ge_u32 s4, 220
    s_cselect_b32 s9, 1342177280, s9
    s_cmp_ge_u32 s4, 240
    s_cselect_b32 s9, 1409286144, s9
    v_mov_b32 v13, s9
    ds_write_b32 v12, v13 offset:16
    s_mov_b32 s60, 1048576
Lpoll_130:
    global_load_dwordx4 v[32:35], v19, s[42:43] offset:0 sc1
    s_waitcnt vmcnt(0)
    v_xor_b32 v32, s98, v32
    v_xor_b32 v33, s99, v33
    v_xor_b32 v34, s100, v34
    v_xor_b32 v35, s101, v35
    v_or_b32 v15, v32, v33
    v_or3_b32 v15, v15, v34, v35
    v_and_b32 v15, 0xff, v15
    v_cmp_ne_u32 vcc, 0, v15
    s_nop 0
    s_cmp_eq_u64 vcc, 0
    s_cbranch_scc1 Lpdone_131
    s_sub_u32 s60, s60, 1
    s_cbranch_scc1 Lpdone_131
    s_sleep 16
    s_branch Lpoll_130
Lpdone_131:
    s_mov_b32 exec_lo, 0xffffffff
    s_mov_b32 exec_hi, 0x0
    global_load_dwordx4 v[36:39], v17, s[42:43] offset:0 sc1
    s_mov_b64 exec, -1
    s_waitcnt vmcnt(0)
    v_permlane32_swap_b32 v36, v38
    v_permlane32_swap_b32 v37, v39
    v_lshlrev_b32 v28, 16, v36
    v_and_b32 v29, 0xffff0000, v36
    v_lshlrev_b32 v30, 16, v37
    v_and_b32 v31, 0xffff0000, v37
    ds_write_b128 v40, v[28:31]
    v_max_f32 v22, v24, v32
    v_sub_f32 v24, v24, v22
    v_sub_f32 v32, v32, v22
    v_mul_f32 v24, 0x3fb8aa3b, v24
    v_mul_f32 v32, 0x3fb8aa3b, v32
    v_exp_f32 v24, v24
    v_exp_f32 v32, v32
    v_mul_f32 v25, v25, v24
    v_mul_f32 v33, v33, v32
    v_add_f32 v25, v25, v33
    v_log_f32 v25, v25
    v_mov_b32 v24, v22
    v_sub_f32 v25, 0, v25
    s_mov_b64 exec, 1
    ds_write_b64 v12, v[24:25] offset:24
    s_lshl_b32 s4, s59, 7
    s_add_u32 s4, s4, 16384
    v_mov_b32 v18, s4
    s_add_u32 s48, s42, s4
    s_addc_u32 s49, s43, 0
    s_mov_b32 s12, 0
    s_mov_b32 s13, 0
    s_mov_b32 s11, 6
L_claim:
    ds_read_b128 v[20:23], v12 offset:32
    s_waitcnt lgkmcnt(0)
    v_max3_u32 v20, v20, v21, v22
    v_max_u32 v20, v20, v23
    s_nop 0
    v_readfirstlane_b32 s4, v20
    s_nop 0
    s_add_u32 s4, s4, s11
    s_add_u32 s5, s12, 60
    s_cmp_ge_u32 s4, s5
    s_cbranch_scc1 L_doclaim
    s_sleep 2
    s_branch L_claim
L_doclaim:
    s_mov_b32 s4, s13
    s_atomic_add s4, s[48:49], 0 glc
    s_waitcnt lgkmcnt(0)
    s_lshl_b32 s6, s12, 1
    s_add_u32 s6, s6, 2
    s_cmp_lt_u32 s6, s4
    s_cselect_b32 s11, 3, 3
    s_cselect_b32 s6, 3, 2
    s_sub_i32 s4, 8, s4
    s_max_i32 s5, s4, 0
    s_min_i32 s5, s5, s13
    s_add_u32 s12, s12, s5
    s_sub_i32 s4, s4, s13
    s_cmp_gt_i32 s4, 0
    s_cselect_b32 s5, 0, 0x10000
    s_or_b32 s5, s5, s12
    s_or_b32 s5, s5, s9
    v_mov_b32 v19, s5
    ds_write_b32 v12, v19 offset:16
    s_lshr_b32 s13, s4, s6
    s_min_u32 s13, s13, 2
    s_max_u32 s13, s13, 1
    s_cmp_gt_i32 s4, 0
    s_cbranch_scc1 L_claim
    s_mov_b64 exec, -1
L_noclaim:
    s_and_b32 s4, s68, 7
    s_lshl_b32 s4, s4, 13
    s_lshl_b32 s5, s61, 11
    s_add_u32 s4, s4, s5
    s_add_u32 s4, s4, 393216
    v_lshl_add_u32 v23, v0, 4, s4
    s_lshl_b32 s5, s61, 10
    v_lshl_add_u32 v24, v0, 3, s5
    s_sub_u32 s4, s26, 64
    s_lshl_b32 s4, s4, 5
    s_mul_i32 s5, s61, 458752
    s_add_u32 s4, s4, s5
    v_lshrrev_b32 v18, 2, v0
    v_mul_u32_u24 v14, 3584, v18
    v_and_b32 v19, 1, v0
    v_lshl_add_u32 v14, v19, 4, v14
    v_add_u32 v14, s4, v14
    v_mov_b32 v16, s28
    v_mov_b32 v17, s29
    v_mov_b32 v12, s30
    v_mov_b32 v13, s31
    v_and_b32 v19, 2, v0
    v_cmp_eq_u32 vcc, 2, v19
    s_nop 1
    v_cndmask_b32 v16, v16, v12, vcc
    v_cndmask_b32 v17, v17, v13, vcc
    v_add_co_u32 v16, vcc, v16, v14
    s_nop 1
    v_addc_co_u32 v17, vcc, 0, v17, vcc
    s_waitcnt vmcnt(0)
    s_waitcnt lgkmcnt(0)
    s_barrier
    ds_read_b128 v[192:195], v226 offset:10240
    ds_read_b128 v[196:199], v226 offset:10304
    ds_read_b128 v[200:203], v226 offset:10368
    ds_read_b128 v[204:207], v226 offset:10432
    s_waitcnt lgkmcnt(3)
    v_mfma_f32_16x16x32_bf16 v[208:211], v[192:195], v[128:131], 0
    v_mfma_f32_16x16x32_bf16 v[212:215], v[192:195], v[144:147], 0
    v_mfma_f32_16x16x32_bf16 v[216:219], v[192:195], v[160:163], 0
    v_mfma_f32_16x16x32_bf16 v[220:223], v[192:195], v[176:179], 0
    s_waitcnt lgkmcnt(2)
    v_mfma_f32_16x16x32_bf16 v[208:211], v[196:199], v[132:135], v[208:211]
    v_mfma_f32_16x16x32_bf16 v[212:215], v[196:199], v[148:151], v[212:215]
    v_mfma_f32_16x16x32_bf16 v[216:219], v[196:199], v[164:167], v[216:219]
    v_mfma_f32_16x16x32_bf16 v[220:223], v[196:199], v[180:183], v[220:223]
    s_waitcnt lgkmcnt(1)
    v_mfma_f32_16x16x32_bf16 v[208:211], v[200:203], v[136:139], v[208:211]
    v_mfma_f32_16x16x32_bf16 v[212:215], v[200:203], v[152:155], v[212:215]
    v_mfma_f32_16x16x32_bf16 v[216:219], v[200:203], v[168:171], v[216:219]
    v_mfma_f32_16x16x32_bf16 v[220:223], v[200:203], v[184:187], v[220:223]
    s_waitcnt lgkmcnt(0)
    v_mfma_f32_16x16x32_bf16 v[208:211], v[204:207], v[140:143], v[208:211]
    v_mfma_f32_16x16x32_bf16 v[212:215], v[204:207], v[156:159], v[212:215]
    v_mfma_f32_16x16x32_bf16 v[216:219], v[204:207], v[172:175], v[216:219]
    v_mfma_f32_16x16x32_bf16 v[220:223], v[204:207], v[188:191], v[220:223]
    s_nop 4
    v_pk_add_f32 v[208:209], v[208:209], v[210:211]
    v_pk_add_f32 v[212:213], v[212:213], v[214:215]
    v_pk_add_f32 v[216:217], v[216:217], v[218:219]
    v_pk_add_f32 v[220:221], v[220:221], v[222:223]
    v_add_f32 v224, v208, v209
    s_nop 1
    v_add_f32_dpp v224, v212, v213 quad_perm:[0,1,2,3] row_mask:0x2 bank_mask:0xf
    s_nop 1
    v_add_f32_dpp v224, v216, v217 quad_perm:[0,1,2,3] row_mask:0x4 bank_mask:0xf
    s_nop 1
    v_add_f32_dpp v224, v220, v221 quad_perm:[0,1,2,3] row_mask:0x8 bank_mask:0xf
    v_bfi_b32 v224, v229, v228, v224
    global_store_dword v227, v224, s[42:43] sc1
    s_barrier
    s_cmp_ge_u32 s2, 224
    s_cbranch_scc1 L_down_s
    s_cmp_ge_u32 s26, 176
    s_cbranch_scc1 L_idle_s
    s_cmp_lt_u32 s2, 64
    s_cbranch_scc1 L_fin_h
    s_lshl_b32 s4, s61, 13
    s_add_u32 s4, s4, 86016
    s_and_b32 s7, s26, 3
    s_lshl_b32 s7, s7, 1
    s_xor_b32 s5, s7, 0
    s_mul_i32 s6, s5, 57344
    s_lshl_b32 s5, s5, 10
    s_add_u32 m0, s4, s5
    v_add_co_u32 v18, vcc, s6, v16
    s_nop 1
    v_addc_co_u32 v19, vcc, 0, v17, vcc
    global_load_lds_dwordx4 v[18:19], off
    s_xor_b32 s5, s7, 1
    s_mul_i32 s6, s5, 57344
    s_lshl_b32 s5, s5, 10
    s_add_u32 m0, s4, s5
    v_add_co_u32 v18, vcc, s6, v16
    s_nop 1
    v_addc_co_u32 v19, vcc, 0, v17, vcc
    global_load_lds_dwordx4 v[18:19], off
    s_xor_b32 s5, s7, 2
    s_mul_i32 s6, s5, 57344
    s_lshl_b32 s5, s5, 10
    s_add_u32 m0, s4, s5
    v_add_co_u32 v18, vcc, s6, v16
    s_nop 1
    v_addc_co_u32 v19, vcc, 0, v17, vcc
    global_load_lds_dwordx4 v[18:19], off
    s_xor_b32 s5, s7, 3
    s_mul_i32 s6, s5, 57344
    s_lshl_b32 s5, s5, 10
    s_add_u32 m0, s4, s5
    v_add_co_u32 v18, vcc, s6, v16
    s_nop 1
    v_addc_co_u32 v19, vcc, 0, v17, vcc
    global_load_lds_dwordx4 v[18:19], off
    s_xor_b32 s5, s7, 4
    s_mul_i32 s6, s5, 57344
    s_lshl_b32 s5, s5, 10
    s_add_u32 m0, s4, s5
    v_add_co_u32 v18, vcc, s6, v16
    s_nop 1
    v_addc_co_u32 v19, vcc, 0, v17, vcc
    global_load_lds_dwordx4 v[18:19], off
    s_xor_b32 s5, s7, 5
    s_mul_i32 s6, s5, 57344
    s_lshl_b32 s5, s5, 10
    s_add_u32 m0, s4, s5
    v_add_co_u32 v18, vcc, s6, v16
    s_nop 1
    v_addc_co_u32 v19, vcc, 0, v17, vcc
    global_load_lds_dwordx4 v[18:19], off
    s_xor_b32 s5, s7, 6
    s_mul_i32 s6, s5, 57344
    s_lshl_b32 s5, s5, 10
    s_add_u32 m0, s4, s5
    v_add_co_u32 v18, vcc, s6, v16
    s_nop 1
    v_addc_co_u32 v19, vcc, 0, v17, vcc
    global_load_lds_dwordx4 v[18:19], off
    s_xor_b32 s5, s7, 7
    s_mul_i32 s6, s5, 57344
    s_lshl_b32 s5, s5, 10
    s_add_u32 m0, s4, s5
    v_add_co_u32 v18, vcc, s6, v16
    s_nop 1
    v_addc_co_u32 v19, vcc, 0, v17, vcc
    global_load_lds_dwordx4 v[18:19], off
    s_waitcnt vmcnt(0)
    s_mov_b64 exec, 1
    v_mov_b32 v12, 0
    v_mov_b32 v13, 1
    s_waitcnt lgkmcnt(0)
    ds_add_u32 v12, v13 offset:52
    s_mov_b64 exec, -1
    s_mov_b32 s6, 0x1
    s_mov_b32 s7, 0x0
    s_and_b32 s4, s69, 7
    s_lshl_b32 s4, s4, 3
    s_lshl_b64 exec, s[6:7], s4
    s_mov_b32 s60, 1048576
Lpoll_132:
    global_load_dwordx4 v[40:43], v23, s[42:43] offset:0 sc1
    s_waitcnt vmcnt(0)
    v_xor_b32 v40, s98, v40
    v_xor_b32 v41, s99, v41
    v_xor_b32 v42, s100, v42
    v_xor_b32 v43, s101, v43
    v_or_b32 v15, v40, v41
    v_or3_b32 v15, v15, v42, v43
    v_and_b32 v15, 0xff, v15
    v_cmp_ne_u32 vcc, 0, v15
    s_nop 0
    s_cmp_eq_u64 vcc, 0
    s_cmp_lg_u64 vcc, exec
    s_cbranch_scc1 Lpdone_133
    s_sub_u32 s60, s60, 1
    s_cbranch_scc1 Lpdone_133
    s_branch Lpoll_132
Lpdone_133:
    s_mov_b64 exec, -1
    s_mov_b32 s60, 1048576
Lpoll_134:
    global_load_dwordx4 v[40:43], v23, s[42:43] offset:0 sc1
    global_load_dwordx4 v[44:47], v23, s[42:43] offset:1024 sc1
    s_waitcnt vmcnt(1)
    v_xor_b32 v40, s98, v40
    v_xor_b32 v41, s99, v41
    v_xor_b32 v42, s100, v42
    v_xor_b32 v43, s101, v43
    s_waitcnt vmcnt(0)
    v_xor_b32 v44, s98, v44
    v_xor_b32 v45, s99, v45
    v_xor_b32 v46, s100, v46
    v_xor_b32 v47, s101, v47
    v_or_b32 v15, v40, v41
    v_or3_b32 v15, v15, v42, v43
    v_or3_b32 v15, v15, v44, v45
    v_or3_b32 v15, v15, v46, v47
    v_and_b32 v15, 0xff, v15
    v_cmp_ne_u32 vcc, 0, v15
    s_nop 0
    s_cmp_eq_u64 vcc, 0
    s_cbranch_scc1 Lpdone_135
    s_sub_u32 s60, s60, 1
    s_cbranch_scc1 Lpdone_135
    s_branch Lpoll_134
Lpdone_135:
    v_pk_mul_f32 v[50:51], v[40:41], v[40:41]
    v_pk_add_f32 v[48:49], v[40:41], v[42:43]
    v_pk_fma_f32 v[50:51], v[42:43], v[42:43], v[50:51]
    v_pk_add_f32 v[52:53], v[44:45], v[46:47]
    v_pk_fma_f32 v[50:51], v[44:45], v[44:45], v[50:51]
    v_pk_add_f32 v[48:49], v[48:49], v[52:53]
    v_pk_fma_f32 v[50:51], v[46:47], v[46:47], v[50:51]
    v_add_f32 v36, v48, v49
    v_add_f32 v37, v50, v51
    s_nop 0
    v_add_f32_dpp v36, v36, v36 row_ror:8 row_mask:0xf bank_mask:0xf
    v_add_f32_dpp v37, v37, v37 row_ror:8 row_mask:0xf bank_mask:0xf
    s_nop 0
    v_add_f32_dpp v36, v36, v36 row_ror:4 row_mask:0xf bank_mask:0xf
    v_add_f32_dpp v37, v37, v37 row_ror:4 row_mask:0xf bank_mask:0xf
    s_nop 0
    v_add_f32_dpp v36, v36, v36 row_ror:2 row_mask:0xf bank_mask:0xf
    v_add_f32_dpp v37, v37, v37 row_ror:2 row_mask:0xf bank_mask:0xf
    s_nop 0
    v_add_f32_dpp v36, v36, v36 row_ror:1 row_mask:0xf bank_mask:0xf
    v_add_f32_dpp v37, v37, v37 row_ror:1 row_mask:0xf bank_mask:0xf
    v_mov_b32 v38, v36
    v_mov_b32 v39, v37
    s_nop 0
    v_permlane16_swap_b32 v36, v38
    v_permlane16_swap_b32 v37, v39
    v_add_f32 v36, v36, v38
    v_add_f32 v37, v37, v39
    v_mov_b32 v38, v36
    v_mov_b32 v39, v37
    s_nop 0
    v_permlane32_swap_b32 v36, v38
    v_permlane32_swap_b32 v37, v39
    v_add_f32 v36, v36, v38
    v_add_f32 v37, v37, v39
    v_mul_f32 v36, 0xbb000000, v36
    v_mul_f32 v37, 0x3b000000, v37
    v_fma_f32 v38, -v36, v36, v37
    v_mov_b32 v37, v36
    v_max_f32 v38, 0, v38
    v_add_f32 v38, 0x3727c5ac, v38
    v_rsq_f32 v38, v38
    v_pk_add_f32 v[40:41], v[40:41], v[36:37]
    v_pk_add_f32 v[42:43], v[42:43], v[36:37]
    v_pk_add_f32 v[44:45], v[44:45], v[36:37]
    v_pk_add_f32 v[46:47], v[46:47], v[36:37]
    v_mov_b32 v39, v38
    v_pk_mul_f32 v[40:41], v[40:41], v[112:113]
    v_pk_mul_f32 v[42:43], v[42:43], v[114:115]
    v_pk_mul_f32 v[44:45], v[44:45], v[116:117]
    v_pk_mul_f32 v[46:47], v[46:47], v[118:119]
    v_pk_fma_f32 v[40:41], v[40:41], v[38:39], v[104:105]
    v_pk_fma_f32 v[42:43], v[42:43], v[38:39], v[106:107]
    v_pk_fma_f32 v[44:45], v[44:45], v[38:39], v[108:109]
    v_pk_fma_f32 v[46:47], v[46:47], v[38:39], v[110:111]
    v_cvt_pk_bf16_f32 v28, v40, v41
    v_cvt_pk_bf16_f32 v29, v42, v43
    v_cvt_pk_bf16_f32 v30, v44, v45
    v_cvt_pk_bf16_f32 v31, v46, v47
    ds_write_b64 v24, v[28:29] offset:14336
    ds_write_b64 v24, v[30:31] offset:14848
    s_waitcnt lgkmcnt(0)
    s_barrier
L_fin_h:
L_end:
    s_endpgm
.section .rodata,"a"
.p2align 6
.amdhsa_kernel adaLN_cond__mha_block_cached__geglu_ffn__decode_kernel
  .amdhsa_next_free_vgpr 256
  .amdhsa_next_free_sgpr 102
  .amdhsa_accum_offset 256
  .amdhsa_group_segment_fixed_size 0
  .amdhsa_kernarg_size 112
  .amdhsa_user_sgpr_count 2
  .amdhsa_user_sgpr_kernarg_segment_ptr 1
  .amdhsa_system_sgpr_workgroup_id_x 1
  .amdhsa_float_denorm_mode_32 3
.end_amdhsa_kernel
```
